```python
import torch

def _softmax(x, axis=-1):
    return torch.softmax(x, dim=axis)
def _gelu(x):
    return torch.nn.functional.gelu(x, approximate="tanh")
def _silu(x):
    return torch.nn.functional.silu(x)
def _sigmoid(x):
    return torch.sigmoid(x)
def _layernorm(x, axis=-1, eps=1e-5):
    m = x.mean(dim=axis, keepdim=True)
    v = x.var(dim=axis, keepdim=True, unbiased=False)
    return (x - m) / torch.sqrt(v + eps)
def _scatter_add(tgt, idx, src, axis=0):
    return tgt.clone().index_add_(axis, idx, src)
def _segment_sum(src, seg, n):
    out = torch.zeros((n,) + src.shape[1:], dtype=src.dtype)
    return out.index_add_(0, seg, src)
def _pad(x, pw):
    flat = tuple(v for pair in reversed(pw) for v in pair)
    return torch.nn.functional.pad(x, flat)

kernel_name = 'gated_mix__spectral_gfnet__ssm_conv_s4__prompt'

def setup_inputs():

    _w = (lambda a: (lambda t: t.to(torch.bfloat16) if t.is_floating_point() else t)(torch.as_tensor(a)))
    def _A_setup():
        B, S, D = 1, 2048, 448
        Df = D // 2 + 1
        return {
            "x": _w((lambda *s: torch.randn(*s, dtype=torch.bfloat16) * 0.05)(B, S, D)),
            "w_r": _w((lambda *s: torch.randn(*s, dtype=torch.bfloat16) * 0.8)(S, Df) * 0.02),
            "w_i": _w((lambda *s: torch.randn(*s, dtype=torch.bfloat16) * 0.8)(S, Df) * 0.02),
        }
    _A_in = _A_setup()

    def _B_setup():
        B, L, D, N = 1, 2048, 448, 256
        A_re = -(lambda _x: torch.exp(torch.as_tensor(_x)))((lambda *s: torch.randn(*s, dtype=torch.bfloat16) * 3.2)(D, N))
        A_im = torch.pi * (lambda *s: torch.randn(*s, dtype=torch.bfloat16) * 0.05)(D, N)
        B_re = (lambda *s: torch.randn(*s, dtype=torch.bfloat16) * 0.05)(D, N)
        B_im = (lambda *s: torch.randn(*s, dtype=torch.bfloat16) * 0.05)(D, N)
        C_re = (lambda *s: torch.randn(*s, dtype=torch.bfloat16) * 0.05)(D, N)
        C_im = (lambda *s: torch.randn(*s, dtype=torch.bfloat16) * 0.1)(D, N)
        log_dt = (lambda *s: torch.randn(*s, dtype=torch.bfloat16) * 0.05)(D) * 0.5 - 4.0
        Dskip = (lambda *s: torch.randn(*s, dtype=torch.bfloat16) * 0.05)(D)
        return {
            "u": _w((lambda *s: torch.randn(*s, dtype=torch.bfloat16) * 0.05)(B, L, D)),
            "A_re": _w(A_re),
            "A_im": _w(A_im),
            "B_re": _w(B_re),
            "B_im": _w(B_im),
            "C_re": _w(C_re),
            "C_im": _w(C_im),
            "log_dt": _w(log_dt),
            "Dskip": _w(Dskip),
        }
    _B_in = _B_setup()

    return {
        "A_x": _A_in["x"],
        "A_w_r": _A_in["w_r"],
        "A_w_i": _A_in["w_i"],
        "B_u": _B_in["u"],
        "B_A_re": _B_in["A_re"],
        "B_A_im": _B_in["A_im"],
        "B_B_re": _B_in["B_re"],
        "B_B_im": _B_in["B_im"],
        "B_C_re": _B_in["C_re"],
        "B_C_im": _B_in["C_im"],
        "B_log_dt": _B_in["log_dt"],
        "B_Dskip": _B_in["Dskip"],
        "gate_w": _w((lambda *s: torch.randn(*s, dtype=torch.bfloat16) * 0.05)(448) * 16.0),
    }

def reference(A_x, A_w_r, A_w_i, B_u, B_A_re, B_A_im, B_B_re, B_B_im, B_C_re, B_C_im, B_log_dt, B_Dskip, gate_w):
    def _A_ref(x, w_r, w_i):
        B, S, D = x.shape
        X = (lambda x, axes=(-2,-1): torch.fft.rfft2(x.float(), dim=axes))(x, axes=(-2, -1))
        W = w_r + 1j * w_i
        X = X * W
        y = (lambda x, s, axes=(-2,-1): torch.fft.irfft2(x, s=s, dim=axes).to(torch.bfloat16))(X, (S, D), axes=(-2, -1))
        return y

    def _B_ref(u, A_re, A_im, B_re, B_im, C_re, C_im, log_dt, Dskip):
        Bsz, L, D = u.shape
        dt = torch.exp(log_dt)[:, None]
        A = A_re + 1j * A_im
        Bc = B_re + 1j * B_im
        Cc = C_re + 1j * C_im
        logdA = dt * A
        dB = dt * Bc
        l = (lambda x, dt: x.to(dt))(torch.arange(L), A_re.dtype)
        P = torch.exp(logdA[:, :, None] * l[None, None, :])
        K = torch.einsum("dn,dnl,dn->dl", Cc, P, dB).real
        L2 = 2 * L
        Kp = _pad(K, ((0, 0), (0, L)))
        up = (lambda x, *d: x.permute(*d))(u, 0, 2, 1)
        up = _pad(up, ((0, 0), (0, 0), (0, L)))
        Kf = (lambda x, axes=(-2,-1): torch.fft.rfft2(x.float(), dim=axes))(Kp[:, None, :], axes=(-2, -1))
        Uf = (lambda x, axes=(-2,-1): torch.fft.rfft2(x.float(), dim=axes))(up[:, :, None, :], axes=(-2, -1))
        Yf = Uf * Kf[None, :, :, :]
        y = (lambda x, s, axes=(-2,-1): torch.fft.irfft2(x, s=s, dim=axes).to(torch.bfloat16))(Yf, (1, L2), axes=(-2, -1))[:, :, 0, :L]
        y = (lambda x, *d: x.permute(*d))(y, 0, 2, 1) + u * Dskip[None, None, :]
        return y

    x = A_x
    g = _sigmoid((x * gate_w).sum(-1, keepdims=True))
    a = _A_ref(x, A_w_r, A_w_i)
    b = _B_ref(x, B_A_re, B_A_im, B_B_re, B_B_im, B_C_re, B_C_im, B_log_dt, B_Dskip)
    return g * a + (1 - g) * b
```

```asm
; @launch grid=(480,1,1) block=(512,1,1) lds=81920
.amdgcn_target "amdgcn-amd-amdhsa--gfx950"
.text
.globl gated_mix__spectral_gfnet__ssm_conv_s4__prompt_kernel
.p2align 8
.type gated_mix__spectral_gfnet__ssm_conv_s4__prompt_kernel,@function
gated_mix__spectral_gfnet__ssm_conv_s4__prompt_kernel:
    s_load_dwordx2 s[4:5], s[0:1], 0
    s_load_dwordx16 s[8:23], s[0:1], 32
    s_load_dwordx2 s[28:29], s[0:1], 120
    s_load_dwordx4 s[64:67], s[0:1], 8
    s_load_dwordx4 s[68:71], s[0:1], 96
    s_setprio 3
    s_cmp_ge_u32 s2, 480
    s_cbranch_scc1 L_end
    s_getpc_b64 s[40:41]
L_pc:
    s_cmp_ge_u32 s2, 64
    s_cbranch_scc1 L_nopf
    s_lshr_b32 s3, s2, 3
    s_mul_i32 s3, s3, 32
    v_subrev_u32 v40, 256, v0
    v_cmp_gt_u32 vcc, 32, v40
    v_add_u32 v40, s3, v40
    v_min_u32 v40, (L_tab_end-L_pc-4)/128, v40
    s_and_saveexec_b64 s[60:61], vcc
    s_cbranch_execz L_nopf
    v_lshlrev_b32 v40, 7, v40
    v_mov_b32 v41, s41
    v_add_co_u32 v40, vcc, s40, v40
    s_nop 1
    v_addc_co_u32 v41, vcc, 0, v41, vcc
    global_load_dword v127, v[40:41], off
L_nopf:
    s_mov_b64 exec, -1
    s_add_u32 s56, s40, k_tables-L_pc
    s_addc_u32 s57, s41, 0
    v_readfirstlane_b32 s34, v0
    v_and_b32 v1, 63, v0
    v_lshlrev_b32 v4, 4, v1
    s_and_b32 s39, s2, 7
    s_mov_b32 s46, 8519680
    s_mov_b32 s30, 0x10000000
    s_mov_b32 s31, 0x20000
    s_mov_b32 s62, 0
    s_lshr_b32 s34, s34, 6
    s_cmp_lt_u32 s2, 256
    s_cbranch_scc1 L_A
    s_mul_i32 s35, s39, 28
    s_bfe_u32 s36, s2, 0x50003
    s_add_u32 s35, s35, s36
    s_lshl_b32 s47, s35, 10
    v_lshl_add_u32 v30, v0, 1, s47
    s_lshl_b32 s47, s35, 2
    s_and_b32 s37, s34, 3
    s_lshl_b32 s3, s37, 10
    v_add_u32 v40, s3, v4
    v_mov_b32 v41, s57
    v_add_co_u32 v40, vcc, s56, v40
    s_add_u32 m0, s3, 69632
    v_and_b32 v42, 15, v0
    v_addc_co_u32 v41, vcc, 0, v41, vcc
    v_mov_b32 v22, v4
    s_waitcnt lgkmcnt(0)
    global_load_short_d16_hi v24, v30, s[8:9] nt
    global_load_short_d16_hi v25, v30, s[10:11] nt
    global_load_short_d16_hi v26, v30, s[12:13] nt
    global_load_short_d16_hi v27, v30, s[14:15] nt
    global_load_short_d16_hi v28, v30, s[16:17] nt
    global_load_short_d16_hi v29, v30, s[18:19] nt
    s_load_dword s48, s[20:21], s47
    s_load_dword s32, s[28:29], s46
    global_load_lds_dwordx4 v[40:41], off
    v_add_co_u32 v40, vcc, 0x1000, v40
    s_sub_u32 s3, 4096, s3
    s_nop 0
    v_addc_co_u32 v41, vcc, 0, v41, vcc
    global_load_dwordx4 v[2:5], v[40:41], off
    v_add_co_u32 v40, vcc, s3, v40
    s_nop 1
    v_addc_co_u32 v41, vcc, 0, v41, vcc
    global_load_dwordx4 v[8:11], v[40:41], off
    s_branch L_B
L_A:
    s_lshr_b32 s42, s2, 3
    s_lshl_b32 s35, s39, 5
    s_add_u32 s35, s35, s42
    s_bfe_u32 s36, s35, 0x40002
    s_and_b32 s38, s35, 0xc0
    s_add_u32 s36, s36, s38
    s_and_b32 s38, s35, 3
    s_lshl_b32 s3, s38, 4
    s_add_u32 s36, s36, s3
    s_mul_i32 s44, s36, 896
    v_and_b32 v2, 15, v0
    v_bfe_u32 v3, v0, 4, 2
    s_lshr_b32 s53, s35, 3
    s_lshl_b32 s53, s53, 2
    s_add_u32 s53, s53, s38
    s_bfe_u32 s58, s35, 0x10002
    s_lshl_b32 s43, s58, 7
    s_add_u32 s43, s43, s53
    s_lshl_b32 s43, s43, 6
    s_cmp_ge_u32 s34, 4
    s_cbranch_scc1 L_Ai2
    s_mul_i32 s38, s34, 229376
    s_add_u32 s38, s38, s44
    s_mul_i32 s3, s34, 1056
    s_add_u32 m0, s3, 0
    s_mov_b32 s6, 1835008
    s_mov_b32 s7, 0x20000
    s_add_u32 s37, s38, 917504
    v_lshlrev_b32 v46, 1, v0
    v_and_b32 v46, 0x1fc, v46
    v_subrev_u32 v47, 896, v4
    v_min_u32 v47, v47, v4
    s_waitcnt lgkmcnt(0)
    buffer_load_dwordx4 v47, s[4:7], s38 offen nt lds
    s_add_u32 m0, m0, 4224
    s_load_dword s32, s[28:29], s46
    buffer_load_dwordx4 v47, s[4:7], s37 offen nt lds
    s_mov_b32 s16, s22
    s_mov_b32 s17, s23
    s_movk_i32 s18, 896
    s_mov_b32 s19, 0x20000
    v_mov_b32 v6, v46
    buffer_load_dword v1, v6, s[16:19], 0 offen
    buffer_load_dword v6, v6, s[16:19], 0 offen offset:512
    s_setprio 2
    v_lshrrev_b32 v96, 3, v2
    v_sub_u32 v116, 0, v96
    v_and_b32 v101, 0x80008000, v116
    s_bitcmp1_b32 s34, 0
    s_cselect_b32 s3, 0x80008000, 0
    v_xor_b32 v117, s3, v101
    v_lshl_add_u32 v96, s34, 1, v96
    v_cvt_f32_u32 v96, v96
    v_bfe_u32 v97, v2, 2, 1
    v_and_b32 v104, 3, v2
    v_mad_u32_u24 v97, v97, 7, v104
    v_cvt_f32_u32 v97, v97
    v_mul_f32 v98, 0xbe000000, v96
    v_mul_f32 v99, 0xbd924925, v97
    v_and_b32 v102, 1, v3
    v_lshrrev_b32 v103, 1, v3
    v_lshl_add_u32 v103, v102, 1, v103
    v_add_u32 v102, -1, v102
    v_lshlrev_b32 v5, 6, v103
    v_cvt_f32_u32 v103, v103
    v_mul_f32 v100, v103, v99
    v_lshrrev_b32 v7, 2, v2
    v_mul_u32_u24 v103, 1056, v7
    v_lshl_add_u32 v5, v104, 3, v5
    v_add_u32 v5, v5, v103
    v_lshl_add_u32 v7, v3, 3, v7
    v_mul_u32_u24 v7, 33280, v7
    v_lshl_add_u32 v7, v104, 4, v7
    v_add_f32 v105, v100, v98
    v_cos_f32 v108, v100
    v_sin_f32 v112, v100
    v_cos_f32 v109, v105
    v_sin_f32 v113, v105
    v_cvt_pk_bf16_f32 v16, v108, v109
    v_cvt_pk_bf16_f32 v32, v112, v113
    v_bfi_b32 v110, v116, v32, v16
    v_bfi_b32 v111, v116, v16, v32
    v_xor_b32 v18, v101, v16
    v_xor_b32 v34, v101, v32
    v_xor_b32 v17, s3, v110
    v_xor_b32 v19, v117, v110
    v_xor_b32 v33, v117, v111
    v_xor_b32 v35, s3, v111
    v_fmamk_f32 v104, v99, 0x40800000, v100
    v_add_f32 v105, v104, v98
    v_cos_f32 v108, v104
    v_sin_f32 v112, v104
    v_cos_f32 v109, v105
    v_sin_f32 v113, v105
    v_cvt_pk_bf16_f32 v20, v108, v109
    v_cvt_pk_bf16_f32 v36, v112, v113
    v_bfi_b32 v110, v116, v36, v20
    v_bfi_b32 v111, v116, v20, v36
    v_xor_b32 v22, v101, v20
    v_xor_b32 v38, v101, v36
    v_xor_b32 v21, s3, v110
    v_xor_b32 v23, v117, v110
    v_xor_b32 v37, v117, v111
    v_xor_b32 v39, s3, v111
    v_fmamk_f32 v104, v99, 0x41000000, v100
    v_add_f32 v105, v104, v98
    v_cos_f32 v108, v104
    v_sin_f32 v112, v104
    v_cos_f32 v109, v105
    v_sin_f32 v113, v105
    v_cvt_pk_bf16_f32 v24, v108, v109
    v_cvt_pk_bf16_f32 v40, v112, v113
    v_bfi_b32 v110, v116, v40, v24
    v_bfi_b32 v111, v116, v24, v40
    v_xor_b32 v26, v101, v24
    v_xor_b32 v42, v101, v40
    v_xor_b32 v25, s3, v110
    v_xor_b32 v27, v117, v110
    v_xor_b32 v41, v117, v111
    v_xor_b32 v43, s3, v111
    v_fmamk_f32 v104, v99, 0x41400000, v100
    v_add_f32 v105, v104, v98
    v_cos_f32 v108, v104
    v_sin_f32 v112, v104
    v_cos_f32 v109, v105
    v_sin_f32 v113, v105
    v_cvt_pk_bf16_f32 v28, v108, v109
    v_cvt_pk_bf16_f32 v44, v112, v113
    v_and_b32 v28, v102, v28
    v_and_b32 v44, v102, v44
    v_bfi_b32 v110, v116, v44, v28
    v_bfi_b32 v111, v116, v28, v44
    v_xor_b32 v30, v101, v28
    v_xor_b32 v46, v101, v44
    v_xor_b32 v29, s3, v110
    v_xor_b32 v31, v117, v110
    v_xor_b32 v45, v117, v111
    v_xor_b32 v47, s3, v111
    v_cvt_f32_u32 v103, s36
    v_mul_f32 v103, 0xba000000, v103
    v_mul_f32 v100, v103, v96
    v_mul_f32 v99, 0xbb124925, v97
    v_lshlrev_b32 v103, 2, v3
    v_cvt_f32_u32 v103, v103
    v_fmac_f32 v100, v103, v99
    v_add_f32 v105, v100, v99
    v_fmamk_f32 v106, v99, 0x40000000, v100
    v_fmamk_f32 v107, v99, 0x40400000, v100
    v_cos_f32 v48, v100
    v_sin_f32 v56, v100
    v_cos_f32 v49, v105
    v_sin_f32 v57, v105
    v_cos_f32 v50, v106
    v_sin_f32 v58, v106
    v_cos_f32 v51, v107
    v_sin_f32 v59, v107
    v_fmamk_f32 v104, v99, 0x41800000, v100
    v_fmamk_f32 v105, v99, 0x41880000, v100
    v_fmamk_f32 v106, v99, 0x41900000, v100
    v_fmamk_f32 v107, v99, 0x41980000, v100
    v_cos_f32 v52, v104
    v_sin_f32 v60, v104
    v_cos_f32 v53, v105
    v_sin_f32 v61, v105
    v_cos_f32 v54, v106
    v_sin_f32 v62, v106
    v_cos_f32 v55, v107
    v_sin_f32 v63, v107
    s_mul_i32 s47, s34, 1064960
    s_add_u32 s46, s43, s47
    s_add_u32 s46, s46, 4259840
    s_add_u32 s47, s46, 16640
    s_add_u32 s48, s46, 133120
    s_add_u32 s49, s46, 149760
    s_mov_b32 vcc_lo, 0x33333333
    s_mov_b32 vcc_hi, 0x33333333
    s_waitcnt vmcnt(2) lgkmcnt(0)
    s_barrier
    ds_read_b64_tr_b16 v[96:97], v5 offset:0
    ds_read_b64_tr_b16 v[98:99], v5 offset:4224
    ds_read_b64_tr_b16 v[100:101], v5 offset:256
    ds_read_b64_tr_b16 v[102:103], v5 offset:4480
    ds_read_b64_tr_b16 v[104:105], v5 offset:512
    ds_read_b64_tr_b16 v[106:107], v5 offset:4736
    ds_read_b64_tr_b16 v[108:109], v5 offset:768
    ds_read_b64_tr_b16 v[110:111], v5 offset:4992
    s_mul_i32 s63, s32, 0x9e3779b1
    s_add_u32 s63, s63, 0x7f4a7c15
    s_mul_i32 s33, s63, 0x9e3779b1
    s_add_u32 s33, s33, 0x7f4a7c15
    s_and_b32 s32, s63, 0x803fffff
    s_or_b32 s32, s32, 0x7f810000
    s_and_b32 s33, s33, 0x803fffff
    s_or_b32 s33, s33, 0x7f810000
    s_waitcnt lgkmcnt(6)
    v_mfma_f32_16x16x32_bf16 v[8:11], v[96:99], v[16:19], 0
    ds_read_b64_tr_b16 v[112:113], v5 offset:32
    ds_read_b64_tr_b16 v[114:115], v5 offset:4256
    v_mfma_f32_16x16x32_bf16 v[12:15], v[96:99], v[32:35], 0
    s_waitcnt lgkmcnt(6)
    v_mfma_f32_16x16x32_bf16 v[8:11], v[100:103], v[20:23], v[8:11]
    ds_read_b64_tr_b16 v[116:117], v5 offset:288
    ds_read_b64_tr_b16 v[118:119], v5 offset:4512
    v_mfma_f32_16x16x32_bf16 v[12:15], v[100:103], v[36:39], v[12:15]
    s_waitcnt lgkmcnt(6)
    v_mfma_f32_16x16x32_bf16 v[8:11], v[104:107], v[24:27], v[8:11]
    ds_read_b64_tr_b16 v[120:121], v5 offset:544
    ds_read_b64_tr_b16 v[122:123], v5 offset:4768
    v_mfma_f32_16x16x32_bf16 v[12:15], v[104:107], v[40:43], v[12:15]
    s_waitcnt lgkmcnt(6)
    v_mfma_f32_16x16x32_bf16 v[8:11], v[108:111], v[28:31], v[8:11]
    ds_read_b64_tr_b16 v[124:125], v5 offset:800
    ds_read_b64_tr_b16 v[126:127], v5 offset:5024
    v_mfma_f32_16x16x32_bf16 v[12:15], v[108:111], v[44:47], v[12:15]
    s_waitcnt lgkmcnt(6)
    v_mfma_f32_16x16x32_bf16 v[96:99], v[112:115], v[16:19], 0
    ds_read_b128 v[64:67], v4 offset:12544
    v_mfma_f32_16x16x32_bf16 v[100:103], v[112:115], v[32:35], 0
    ds_read_b128 v[80:83], v4 offset:13568
    s_waitcnt lgkmcnt(6)
    v_mfma_f32_16x16x32_bf16 v[96:99], v[116:119], v[20:23], v[96:99]
    ds_read_b128 v[68:71], v4 offset:14592
    v_mfma_f32_16x16x32_bf16 v[100:103], v[116:119], v[36:39], v[100:103]
    ds_read_b128 v[84:87], v4 offset:15616
    s_waitcnt lgkmcnt(6)
    v_mfma_f32_16x16x32_bf16 v[96:99], v[120:123], v[24:27], v[96:99]
    ds_read_b128 v[72:75], v4 offset:16640
    v_mfma_f32_16x16x32_bf16 v[100:103], v[120:123], v[40:43], v[100:103]
    ds_read_b128 v[88:91], v4 offset:17664
    s_waitcnt lgkmcnt(6)
    v_mfma_f32_16x16x32_bf16 v[96:99], v[124:127], v[28:31], v[96:99]
    ds_read_b128 v[76:79], v4 offset:18688
    v_mfma_f32_16x16x32_bf16 v[100:103], v[124:127], v[44:47], v[100:103]
    ds_read_b128 v[92:95], v4 offset:19712
    v_pk_mul_f32 v[104:105], v[8:9], v[48:49]
    v_pk_mul_f32 v[106:107], v[8:9], v[56:57]
    v_pk_mul_f32 v[108:109], v[10:11], v[50:51]
    v_pk_mul_f32 v[110:111], v[10:11], v[58:59]
    v_pk_fma_f32 v[8:9], v[12:13], v[56:57], v[104:105] neg_lo:[1,0,0] neg_hi:[1,0,0]
    v_pk_fma_f32 v[12:13], v[12:13], v[48:49], v[106:107]
    v_pk_fma_f32 v[10:11], v[14:15], v[58:59], v[108:109] neg_lo:[1,0,0] neg_hi:[1,0,0]
    v_pk_fma_f32 v[14:15], v[14:15], v[50:51], v[110:111]
    v_cvt_pk_bf16_f32 v112, v8, v12
    v_cvt_pk_bf16_f32 v113, v9, v13
    v_cvt_pk_bf16_f32 v114, v10, v14
    v_cvt_pk_bf16_f32 v115, v11, v15
    s_waitcnt lgkmcnt(4)
    s_nop 0
    v_mfma_f32_16x16x32_bf16 v[16:19], v[112:115], v[64:67], 0
    v_mfma_f32_16x16x32_bf16 v[20:23], v[112:115], v[80:83], 0
    v_mfma_f32_16x16x32_bf16 v[24:27], v[112:115], v[68:71], 0
    v_mfma_f32_16x16x32_bf16 v[28:31], v[112:115], v[84:87], 0
    v_pk_mul_f32 v[104:105], v[96:97], v[52:53]
    v_pk_mul_f32 v[106:107], v[96:97], v[60:61]
    v_pk_mul_f32 v[108:109], v[98:99], v[54:55]
    v_pk_mul_f32 v[110:111], v[98:99], v[62:63]
    v_pk_fma_f32 v[96:97], v[100:101], v[60:61], v[104:105] neg_lo:[1,0,0] neg_hi:[1,0,0]
    v_pk_fma_f32 v[100:101], v[100:101], v[52:53], v[106:107]
    v_pk_fma_f32 v[98:99], v[102:103], v[62:63], v[108:109] neg_lo:[1,0,0] neg_hi:[1,0,0]
    v_pk_fma_f32 v[102:103], v[102:103], v[54:55], v[110:111]
    v_cvt_pk_bf16_f32 v116, v96, v100
    v_cvt_pk_bf16_f32 v117, v97, v101
    v_cvt_pk_bf16_f32 v118, v98, v102
    v_cvt_pk_bf16_f32 v119, v99, v103
    s_waitcnt lgkmcnt(0)
    s_nop 0
    v_mfma_f32_16x16x32_bf16 v[16:19], v[116:119], v[72:75], v[16:19]
    v_mfma_f32_16x16x32_bf16 v[20:23], v[116:119], v[88:91], v[20:23]
    v_mfma_f32_16x16x32_bf16 v[24:27], v[116:119], v[76:79], v[24:27]
    v_mfma_f32_16x16x32_bf16 v[28:31], v[116:119], v[92:95], v[28:31]
    v_mov_b32 v33, s32
    v_mov_b32 v35, s33
    v_mov_b32 v37, s32
    v_mov_b32 v39, s33
    v_mov_b32 v41, s32
    v_mov_b32 v43, s33
    v_mov_b32 v45, s32
    v_mov_b32 v47, s33
    v_cvt_pk_bf16_f32 v8, v16, v20
    v_cvt_pk_bf16_f32 v9, v17, v21
    v_cvt_pk_bf16_f32 v10, v18, v22
    v_cvt_pk_bf16_f32 v11, v19, v23
    v_cvt_pk_bf16_f32 v12, v24, v28
    v_cvt_pk_bf16_f32 v13, v25, v29
    v_cvt_pk_bf16_f32 v14, v26, v30
    v_cvt_pk_bf16_f32 v15, v27, v31
    v_cndmask_b32_dpp v32, v10, v8, vcc quad_perm:[2,3,0,1] row_mask:0xf bank_mask:0xf
    v_cndmask_b32_dpp v34, v11, v9, vcc quad_perm:[2,3,0,1] row_mask:0xf bank_mask:0xf
    buffer_store_dwordx4 v[32:35], v7, s[28:31], s46 offen sc1
    v_cndmask_b32_dpp v40, v14, v12, vcc quad_perm:[2,3,0,1] row_mask:0xf bank_mask:0xf
    v_cndmask_b32_dpp v42, v15, v13, vcc quad_perm:[2,3,0,1] row_mask:0xf bank_mask:0xf
    buffer_store_dwordx4 v[40:43], v7, s[28:31], s48 offen sc1
    s_not_b64 vcc, vcc
    v_cndmask_b32_dpp v36, v8, v10, vcc quad_perm:[2,3,0,1] row_mask:0xf bank_mask:0xf
    v_cndmask_b32_dpp v38, v9, v11, vcc quad_perm:[2,3,0,1] row_mask:0xf bank_mask:0xf
    buffer_store_dwordx4 v[36:39], v7, s[28:31], s47 offen sc1
    v_cndmask_b32_dpp v44, v12, v14, vcc quad_perm:[2,3,0,1] row_mask:0xf bank_mask:0xf
    v_cndmask_b32_dpp v46, v13, v15, vcc quad_perm:[2,3,0,1] row_mask:0xf bank_mask:0xf
    buffer_store_dwordx4 v[44:47], v7, s[28:31], s49 offen sc1
    s_barrier
    s_bfe_u32 s45, s42, 0x10003
    s_sub_u32 s37, 8, s39
    s_and_b32 s37, s37, 7
    s_cmp_eq_u32 s45, 0
    s_cselect_b32 s37, s39, s37
    s_lshl_b32 s57, s53, 1
    s_add_u32 s57, s57, s58
    s_lshl_b32 s57, s57, 5
    s_lshl_b32 s53, s53, 7
    s_add_u32 s53, s53, 8523776
    s_lshl_b32 s58, s58, 3
    s_or_b32 s58, s58, s34
    s_mov_b32 s24, s70
    s_mov_b32 s25, s71
    s_mov_b32 s26, 1835008
    s_mov_b32 s27, 0x20000
    s_lshr_b32 s54, s34, 1
    s_mul_i32 s54, s54, 2080
    s_and_b32 s3, s34, 1
    s_lshl_b32 s38, s3, 10
    s_add_u32 s54, s54, s38
    s_lshr_b32 s55, s34, 2
    s_mul_i32 s55, s55, 4160
    s_lshl_b32 s38, s3, 11
    s_add_u32 s55, s55, s38
    s_lshl_b32 s38, s34, 9
    s_and_b32 s38, s38, 1024
    s_add_u32 s55, s55, s38
    s_add_u32 s55, s55, 71424
    s_add_u32 s40, s57, 0
    s_add_u32 s57, s57, 4259840
    s_and_b32 s3, s34, 5
    s_mov_b32 s51, 0x36124925
    s_cselect_b32 s50, s51, 0x35924925
    s_mov_b32 s51, s50
    s_lshl_b32 s52, s37, 5
    s_add_u32 s52, s52, s42
    s_mul_i32 s52, s52, 16640
    s_add_u32 s52, s52, 4259840
    s_mul_i32 s59, s34, 1152
    s_add_u32 s59, s59, 45568
    v_add_u32 v14, s55, v4
    v_add_u32 v10, s54, v4
    v_and_b32 v12, 1, v0
    v_mul_u32_u24 v15, 4160, v12
    v_lshrrev_b32 v11, 4, v0
    v_lshl_add_u32 v15, v11, 5, v15
    v_bfe_u32 v11, v0, 1, 1
    v_lshl_add_u32 v15, v11, 4, v15
    v_and_b32 v11, 12, v0
    v_add_u32 v11, 71424, v11
    v_add_u32 v15, v15, v11
    v_lshrrev_b32 v11, 1, v0
    v_mul_u32_u24 v13, 16640, v11
    v_lshl_add_u32 v13, v12, 4, v13
    v_lshlrev_b32 v11, 4, v0
    v_lshrrev_b32 v8, 4, v0
    v_and_b32 v12, 3, v0
    v_mul_u32_u24 v9, 2080, v12
    v_lshl_add_u32 v9, v8, 5, v9
    v_and_b32 v8, 12, v0
    v_add_u32 v8, 28928, v8
    v_add_u32 v9, v9, v8
    v_add_u32 v8, 16, v9
    s_add_u32 s47, s52, 4096
    s_add_u32 s48, s52, 8192
    s_add_u32 s49, s52, 12288
    s_setprio 1
    v_and_b32 v80, 1, v0
    v_lshlrev_b32 v81, 4, v80
    v_lshrrev_b32 v82, 1, v0
    v_mul_u32_u24 v83, 4224, v80
    v_lshl_add_u32 v83, v82, 2, v83
    ds_read_b32 v64, v83 offset:0
    ds_read_b32 v65, v83 offset:1056
    ds_read_b32 v66, v83 offset:2112
    ds_read_b32 v67, v83 offset:3168
    ds_read_b32 v68, v83 offset:512
    ds_read_b32 v69, v83 offset:1568
    ds_read_b32 v70, v83 offset:2624
    ds_read_b32 v71, v83 offset:3680
    v_min_u32 v77, 95, v82
    v_mul_u32_u24 v77, 16640, v77
    v_add_u32 v77, v77, v81
    v_mul_u32_u24 v78, 8256, v80
    v_lshl_add_u32 v78, v82, 3, v78
    v_add_u32 v78, 54912, v78
    v_mul_u32_u24 v79, 917504, v80
    v_lshl_add_u32 v79, v82, 2, v79
    s_cmp_eq_u32 s34, 3
    s_cselect_b32 s3, 0x40000000, 0
    v_add_u32 v80, s3, v79
    v_mov_b32 v76, v13
    s_add_u32 s41, s40, 2129920
    s_add_u32 s45, s44, 229376
    s_add_u32 s46, s44, 458752
    s_add_u32 s43, s44, 688128
    s_waitcnt lgkmcnt(0)
    s_setprio 2
    s_waitcnt vmcnt(0)
    s_barrier
    buffer_load_dwordx4 v[112:115], v11, s[28:31], s52 offen sc1
    buffer_load_dwordx4 v[116:119], v11, s[28:31], s47 offen sc1
    buffer_load_dwordx4 v[120:123], v11, s[28:31], s48 offen sc1
    buffer_load_dwordx4 v[124:127], v11, s[28:31], s49 offen sc1
    ds_read_b128 v[16:19], v4 offset:8448
    ds_read_b128 v[20:23], v4 offset:9472
    ds_read_b128 v[24:27], v4 offset:10496
    ds_read_b128 v[28:31], v4 offset:11520
    v_lshlrev_b32 v48, 16, v1
    v_and_b32 v49, 0xffff0000, v1
    v_lshlrev_b32 v96, 16, v64
    v_and_b32 v97, 0xffff0000, v64
    v_lshlrev_b32 v98, 16, v65
    v_and_b32 v99, 0xffff0000, v65
    v_lshlrev_b32 v100, 16, v66
    v_and_b32 v101, 0xffff0000, v66
    v_lshlrev_b32 v102, 16, v67
    v_and_b32 v103, 0xffff0000, v67
    v_pk_mul_f32 v[96:97], v[96:97], v[48:49]
    v_pk_mul_f32 v[98:99], v[98:99], v[48:49]
    v_pk_mul_f32 v[100:101], v[100:101], v[48:49]
    v_pk_mul_f32 v[102:103], v[102:103], v[48:49]
    v_lshlrev_b32 v48, 16, v6
    v_and_b32 v49, 0xffff0000, v6
    v_lshlrev_b32 v104, 16, v68
    v_and_b32 v105, 0xffff0000, v68
    v_lshlrev_b32 v106, 16, v69
    v_and_b32 v107, 0xffff0000, v69
    v_lshlrev_b32 v108, 16, v70
    v_and_b32 v109, 0xffff0000, v70
    v_lshlrev_b32 v110, 16, v71
    v_and_b32 v111, 0xffff0000, v71
    v_pk_mul_f32 v[104:105], v[104:105], v[48:49]
    v_pk_mul_f32 v[106:107], v[106:107], v[48:49]
    v_pk_mul_f32 v[108:109], v[108:109], v[48:49]
    v_pk_mul_f32 v[110:111], v[110:111], v[48:49]
Lyg:
    s_waitcnt vmcnt(0)
    v_xor_b32 v12, s32, v113
    v_bitop3_b32 v12, v115, s33, v12 bitop3:0xbe
    v_bitop3_b32 v12, v117, s32, v12 bitop3:0xbe
    v_bitop3_b32 v12, v119, s33, v12 bitop3:0xbe
    v_bitop3_b32 v12, v121, s32, v12 bitop3:0xbe
    v_bitop3_b32 v12, v123, s33, v12 bitop3:0xbe
    v_bitop3_b32 v12, v125, s32, v12 bitop3:0xbe
    v_bitop3_b32 v12, v127, s33, v12 bitop3:0xbe
    v_cmp_ne_u32 vcc, 0, v12
    s_cmp_lg_u64 vcc, 0
    s_cbranch_scc0 Lyg_ok
    s_mov_b64 exec, vcc
    s_sleep 1
    s_add_u32 s62, s62, 1
    s_cmp_gt_u32 s62, 400000
    s_cbranch_scc1 Lyg_ok
    buffer_load_dwordx4 v[112:115], v11, s[28:31], s52 offen sc1
    buffer_load_dwordx4 v[116:119], v11, s[28:31], s47 offen sc1
    buffer_load_dwordx4 v[120:123], v11, s[28:31], s48 offen sc1
    buffer_load_dwordx4 v[124:127], v11, s[28:31], s49 offen sc1
    s_branch Lyg
Lyg_ok:
    s_mov_b64 exec, -1
    ds_write2st64_b32 v9, v112, v114 offset0:0 offset1:4
    ds_write2st64_b32 v9, v116, v118 offset0:2 offset1:6
    ds_write2st64_b32 v8, v120, v122 offset0:0 offset1:4
    ds_write2st64_b32 v8, v124, v126 offset0:2 offset1:6
    s_branch L_Acommon
L_Ai2:
    s_and_b32 s3, s34, 1
    v_lshl_add_u32 v48, s3, 4, v2
    v_cvt_f32_u32 v48, v48
    v_mul_f32 v48, 0xbd000000, v48
    s_lshl_b32 s3, s34, 3
    s_and_b32 s3, s3, 16
    v_lshl_add_u32 v49, v3, 2, s3
    v_cvt_f32_u32 v49, v49
    v_mul_f32 v49, v49, v48
    v_lshl_add_u32 v50, s34, 11, v4
    v_add_f32 v53, v49, v48
    v_fmamk_f32 v54, v48, 0x40000000, v49
    v_fmamk_f32 v55, v48, 0x40400000, v49
    v_cos_f32 v56, v49
    v_sin_f32 v60, v49
    v_cos_f32 v57, v53
    v_sin_f32 v61, v53
    v_cos_f32 v58, v54
    v_sin_f32 v62, v54
    v_cos_f32 v59, v55
    v_sin_f32 v63, v55
    v_cvt_pk_bf16_f32 v64, v56, -v60
    v_cvt_pk_bf16_f32 v68, v60, v56
    v_cvt_pk_bf16_f32 v65, v57, -v61
    v_cvt_pk_bf16_f32 v69, v61, v57
    v_cvt_pk_bf16_f32 v66, v58, -v62
    v_cvt_pk_bf16_f32 v70, v62, v58
    v_cvt_pk_bf16_f32 v67, v59, -v63
    v_cvt_pk_bf16_f32 v71, v63, v59
    ds_write_b128 v50, v[64:67] offset:4352
    ds_write_b128 v50, v[68:71] offset:5376
    v_and_b32 v47, 0x7c, v0
    s_waitcnt lgkmcnt(0)
    s_load_dword s32, s[28:29], s46
    s_cmp_ge_u32 s34, 6
    s_cbranch_scc1 L_Awl
    global_load_dword v120, v47, s[68:69] offset:0
    global_load_dword v121, v47, s[68:69] offset:128
    global_load_dword v122, v47, s[68:69] offset:256
    global_load_dword v123, v47, s[68:69] offset:384
    global_load_dword v124, v47, s[68:69] offset:512
    global_load_dword v125, v47, s[68:69] offset:640
    global_load_dword v126, v47, s[68:69] offset:768
    s_setprio 2
    v_and_b32 v9, 3, v0
    v_mul_u32_u24 v8, 2112, v9
    v_add_u32 v8, v8, v47
    v_mul_u32_u24 v46, 4160, v47
    v_lshl_add_u32 v46, v9, 4, v46
    s_add_u32 s46, s43, 0
    s_lshl_b32 s3, s34, 5
    v_lshl_add_u32 v9, v9, 3, s3
    s_barrier
    ds_read_b32 v16, v8 offset:0
    ds_read_b32 v18, v8 offset:1056
    ds_read_b32 v20, v8 offset:128
    ds_read_b32 v22, v8 offset:1184
    ds_read_b32 v24, v8 offset:256
    ds_read_b32 v26, v8 offset:1312
    ds_read_b32 v28, v8 offset:384
    ds_read_b32 v30, v8 offset:1440
    ds_read_b32 v32, v8 offset:512
    ds_read_b32 v34, v8 offset:1568
    ds_read_b32 v36, v8 offset:640
    ds_read_b32 v38, v8 offset:1696
    ds_read_b32 v40, v8 offset:768
    ds_read_b32 v42, v8 offset:1824
    s_waitcnt lgkmcnt(0)
    s_mul_i32 s63, s32, 0x9e3779b1
    s_add_u32 s63, s63, 0x7f4a7c15
    s_mul_i32 s33, s63, 0x9e3779b1
    s_add_u32 s33, s33, 0x7f4a7c15
    s_and_b32 s32, s63, 0x803fffff
    s_or_b32 s32, s32, 0x7f810000
    s_and_b32 s33, s33, 0x803fffff
    s_or_b32 s33, s33, 0x7f810000
    v_mov_b32 v17, s32
    v_mov_b32 v19, s33
    v_mov_b32 v21, s32
    v_mov_b32 v23, s33
    v_mov_b32 v25, s32
    v_mov_b32 v27, s33
    v_mov_b32 v29, s32
    v_mov_b32 v31, s33
    v_mov_b32 v33, s32
    v_mov_b32 v35, s33
    v_mov_b32 v37, s32
    v_mov_b32 v39, s33
    v_mov_b32 v41, s32
    v_mov_b32 v43, s33
    s_bfe_u32 s45, s42, 0x10003
    s_sub_u32 s37, 8, s39
    s_and_b32 s37, s37, 7
    s_cmp_eq_u32 s45, 0
    s_cselect_b32 s37, s39, s37
    s_lshl_b32 s57, s53, 1
    s_add_u32 s57, s57, s58
    s_lshl_b32 s57, s57, 5
    s_lshl_b32 s53, s53, 7
    s_add_u32 s53, s53, 8523776
    s_lshl_b32 s58, s58, 3
    s_or_b32 s58, s58, s34
    s_mov_b32 s24, s70
    s_mov_b32 s25, s71
    s_mov_b32 s26, 1835008
    s_mov_b32 s27, 0x20000
    s_lshr_b32 s54, s34, 1
    s_mul_i32 s54, s54, 2080
    s_and_b32 s3, s34, 1
    s_lshl_b32 s38, s3, 10
    s_add_u32 s54, s54, s38
    s_lshr_b32 s55, s34, 2
    s_mul_i32 s55, s55, 4160
    s_lshl_b32 s38, s3, 11
    s_add_u32 s55, s55, s38
    s_lshl_b32 s38, s34, 9
    s_and_b32 s38, s38, 1024
    s_add_u32 s55, s55, s38
    s_add_u32 s55, s55, 71424
    s_add_u32 s40, s57, 0
    s_add_u32 s57, s57, 4259840
    s_and_b32 s3, s34, 5
    s_mov_b32 s51, 0x36124925
    s_cselect_b32 s50, s51, 0x35924925
    s_mov_b32 s51, s50
    s_lshl_b32 s52, s37, 5
    s_add_u32 s52, s52, s42
    s_mul_i32 s52, s52, 16640
    s_add_u32 s52, s52, 4259840
    s_mul_i32 s59, s34, 1152
    s_add_u32 s59, s59, 45568
    s_barrier
    buffer_store_dwordx4 v[16:19], v46, s[28:31], s46 offen sc1
    s_add_u32 s46, s46, 532480
    buffer_store_dwordx4 v[20:23], v46, s[28:31], s46 offen sc1
    s_add_u32 s46, s46, 532480
    buffer_store_dwordx4 v[24:27], v46, s[28:31], s46 offen sc1
    s_add_u32 s46, s46, 532480
    buffer_store_dwordx4 v[28:31], v46, s[28:31], s46 offen sc1
    s_add_u32 s46, s46, 532480
    buffer_store_dwordx4 v[32:35], v46, s[28:31], s46 offen sc1
    s_add_u32 s46, s46, 532480
    buffer_store_dwordx4 v[36:39], v46, s[28:31], s46 offen sc1
    s_add_u32 s46, s46, 532480
    buffer_store_dwordx4 v[40:43], v46, s[28:31], s46 offen sc1
    s_cmp_eq_u32 s34, 4
    s_mov_b32 s3, 0xbd800000
    s_cselect_b32 s3, s3, 0xbb800000
    v_cvt_f32_u32 v48, v2
    v_lshlrev_b32 v49, 2, v3
    v_cvt_f32_u32 v49, v49
    v_mul_f32 v48, s3, v48
    v_mul_f32 v49, v49, v48
    v_mov_b32 v52, v49
    v_add_f32 v53, v49, v48
    v_fmamk_f32 v54, v48, 0x40000000, v49
    v_fmamk_f32 v55, v48, 0x40400000, v49
    v_cos_f32 v80, v52
    v_sin_f32 v84, v52
    v_cos_f32 v81, v53
    v_sin_f32 v85, v53
    v_cos_f32 v82, v54
    v_sin_f32 v86, v54
    v_cos_f32 v83, v55
    v_sin_f32 v87, v55
    s_cbranch_scc0 L_t256
    v_cvt_pk_bf16_f32 v56, v80, -v84
    v_cvt_pk_bf16_f32 v84, v84, v80
    v_mov_b32 v80, v56
    v_cvt_pk_bf16_f32 v57, v81, -v85
    v_cvt_pk_bf16_f32 v85, v85, v81
    v_mov_b32 v81, v57
    v_cvt_pk_bf16_f32 v58, v82, -v86
    v_cvt_pk_bf16_f32 v86, v86, v82
    v_mov_b32 v82, v58
    v_cvt_pk_bf16_f32 v59, v83, -v87
    v_cvt_pk_bf16_f32 v87, v87, v83
    v_mov_b32 v83, v59
L_t256:
    s_nop 1
    ds_write_b128 v50, v[80:83] offset:256
    ds_write_b128 v50, v[84:87] offset:1280
    v_mov_b32 v116, 0
    v_mov_b32 v114, s32
    v_mov_b32 v115, s33
    s_waitcnt vmcnt(0) lgkmcnt(0)
    s_barrier
    s_cmp_lg_u32 s58, 4
    s_cbranch_scc1 L_nofw
    s_mov_b64 exec, 1
    buffer_store_dwordx2 v[114:115], v116, s[28:31], s53 offen sc1
    s_mov_b64 exec, -1
L_nofw:
    s_setprio 0
    v_dot2_f32_bf16 v44, v16, v120, 0
    v_dot2_f32_bf16 v45, v18, v120, 0
    v_dot2_f32_bf16 v44, v20, v121, v44
    v_dot2_f32_bf16 v45, v22, v121, v45
    v_dot2_f32_bf16 v44, v24, v122, v44
    v_dot2_f32_bf16 v45, v26, v122, v45
    v_dot2_f32_bf16 v44, v28, v123, v44
    v_dot2_f32_bf16 v45, v30, v123, v45
    v_dot2_f32_bf16 v44, v32, v124, v44
    v_dot2_f32_bf16 v45, v34, v124, v45
    v_dot2_f32_bf16 v44, v36, v125, v44
    v_dot2_f32_bf16 v45, v38, v125, v45
    v_dot2_f32_bf16 v44, v40, v126, v44
    v_dot2_f32_bf16 v45, v42, v126, v45
    s_nop 1
    v_add_f32_dpp v44, v44, v44 row_ror:4 row_mask:0xf bank_mask:0xf
    v_add_f32_dpp v45, v45, v45 row_ror:4 row_mask:0xf bank_mask:0xf
    s_nop 0
    v_add_f32_dpp v44, v44, v44 row_ror:8 row_mask:0xf bank_mask:0xf
    v_add_f32_dpp v45, v45, v45 row_ror:8 row_mask:0xf bank_mask:0xf
    v_mov_b32 v48, v44
    v_mov_b32 v49, v45
    s_nop 0
    v_permlane16_swap_b32 v44, v48
    v_permlane16_swap_b32 v45, v49
    v_add_f32 v44, v44, v48
    v_add_f32 v45, v45, v49
    v_mov_b32 v48, v44
    v_mov_b32 v49, v45
    s_nop 0
    v_permlane32_swap_b32 v44, v48
    v_permlane32_swap_b32 v45, v49
    v_add_f32 v44, v44, v48
    v_add_f32 v45, v45, v49
    ds_write_b64 v9, v[44:45] offset:54656
    v_add_u32 v14, s55, v4
    v_add_u32 v10, s54, v4
    v_and_b32 v12, 1, v0
    v_mul_u32_u24 v15, 4160, v12
    v_lshrrev_b32 v11, 4, v0
    v_lshl_add_u32 v15, v11, 5, v15
    v_bfe_u32 v11, v0, 1, 1
    v_lshl_add_u32 v15, v11, 4, v15
    v_and_b32 v11, 12, v0
    v_add_u32 v11, 71424, v11
    v_add_u32 v15, v15, v11
    v_lshrrev_b32 v11, 1, v0
    v_mul_u32_u24 v13, 16640, v11
    v_lshl_add_u32 v13, v12, 4, v13
    v_lshlrev_b32 v11, 4, v0
    v_cvt_f32_u32 v48, s36
    v_mul_f32 v48, 0x3a000000, v48
    v_cvt_f32_u32 v51, v3
    v_mul_f32 v9, v51, v48
    s_and_b32 s3, s34, 3
    v_lshl_add_u32 v50, s3, 4, v2
    v_cvt_f32_u32 v50, v50
    v_mul_f32 v8, 0x3b124925, v50
    v_add_f32 v53, v9, v8
    v_fmamk_f32 v54, v8, 0x40000000, v9
    v_fmamk_f32 v55, v8, 0x40400000, v9
    v_cos_f32 v96, v9
    v_sin_f32 v104, v9
    v_cos_f32 v97, v53
    v_sin_f32 v105, v53
    v_cos_f32 v98, v54
    v_sin_f32 v106, v54
    v_cos_f32 v99, v55
    v_sin_f32 v107, v55
    v_fmac_f32 v9, 4.0, v48
    v_add_f32 v53, v9, v8
    v_fmamk_f32 v54, v8, 0x40000000, v9
    v_fmamk_f32 v55, v8, 0x40400000, v9
    v_cos_f32 v100, v9
    v_sin_f32 v108, v9
    v_cos_f32 v101, v53
    v_sin_f32 v109, v53
    v_cos_f32 v102, v54
    v_sin_f32 v110, v54
    v_cos_f32 v103, v55
    v_sin_f32 v111, v55
    v_mul_f32 v50, 0x3c800000, v50
    v_mul_f32 v49, 0x41000000, v51
    v_mul_f32 v49, v49, v50
    v_and_b32 v48, 1, v2
    v_sub_u32 v48, 0, v48
    v_and_b32 v48, 0x80008000, v48
    v_fmamk_f32 v53, v50, 0x40000000, v49
    v_fmamk_f32 v54, v50, 0x40800000, v49
    v_fmamk_f32 v55, v50, 0x40c00000, v49
    v_cos_f32 v56, v49
    v_sin_f32 v60, v49
    v_cos_f32 v57, v53
    v_sin_f32 v61, v53
    v_cos_f32 v58, v54
    v_sin_f32 v62, v54
    v_cos_f32 v59, v55
    v_sin_f32 v63, v55
    v_cvt_pk_bf16_f32 v64, v56, -v60
    v_cvt_pk_bf16_f32 v80, v60, v56
    v_cvt_pk_bf16_f32 v65, v57, -v61
    v_cvt_pk_bf16_f32 v81, v61, v57
    v_cvt_pk_bf16_f32 v66, v58, -v62
    v_cvt_pk_bf16_f32 v82, v62, v58
    v_cvt_pk_bf16_f32 v67, v59, -v63
    v_cvt_pk_bf16_f32 v83, v63, v59
    v_xor_b32 v68, v48, v64
    v_xor_b32 v84, v48, v80
    v_xor_b32 v69, v48, v65
    v_xor_b32 v85, v48, v81
    v_xor_b32 v70, v48, v66
    v_xor_b32 v86, v48, v82
    v_xor_b32 v71, v48, v67
    v_xor_b32 v87, v48, v83
    v_add_f32 v52, v49, v50
    v_fmamk_f32 v53, v50, 0x40400000, v49
    v_fmamk_f32 v54, v50, 0x40a00000, v49
    v_fmamk_f32 v55, v50, 0x40e00000, v49
    v_cos_f32 v56, v52
    v_sin_f32 v60, v52
    v_cos_f32 v57, v53
    v_sin_f32 v61, v53
    v_cos_f32 v58, v54
    v_sin_f32 v62, v54
    v_cos_f32 v59, v55
    v_sin_f32 v63, v55
    v_cvt_pk_bf16_f32 v72, v56, -v60
    v_cvt_pk_bf16_f32 v88, v60, v56
    v_cvt_pk_bf16_f32 v73, v57, -v61
    v_cvt_pk_bf16_f32 v89, v61, v57
    v_cvt_pk_bf16_f32 v74, v58, -v62
    v_cvt_pk_bf16_f32 v90, v62, v58
    v_cvt_pk_bf16_f32 v75, v59, -v63
    v_cvt_pk_bf16_f32 v91, v63, v59
    v_xor_b32 v76, v48, v72
    v_xor_b32 v92, v48, v88
    v_xor_b32 v77, v48, v73
    v_xor_b32 v93, v48, v89
    v_xor_b32 v78, v48, v74
    v_xor_b32 v94, v48, v90
    v_xor_b32 v79, v48, v75
    v_xor_b32 v95, v48, v91
    v_and_b32 v48, 7, v2
    v_mul_u32_u24 v49, v48, v3
    v_cvt_f32_u32 v49, v49
    v_mul_f32 v49, 0x3e000000, v49
    v_and_b32 v48, 1, v2
    v_sub_u32 v48, 0, v48
    v_and_b32 v48, 0x80008000, v48
    s_and_b32 s3, s34, 3
    v_lshrrev_b32 v51, 3, v2
    v_lshl_add_u32 v51, s3, 1, v51
    v_cvt_f32_u32 v51, v51
    v_mul_f32 v51, 0x3e124925, v51
    v_lshl_add_u32 v50, s3, 11, v4
    v_add_f32 v53, v49, v51
    v_fmamk_f32 v54, v51, 0x40000000, v49
    v_fmamk_f32 v55, v51, 0x40400000, v49
    v_cos_f32 v56, v49
    v_sin_f32 v60, v49
    v_cos_f32 v57, v53
    v_sin_f32 v61, v53
    v_cos_f32 v58, v54
    v_sin_f32 v62, v54
    v_cos_f32 v59, v55
    v_sin_f32 v63, v55
    v_cvt_pk_bf16_f32 v16, v56, -v60
    v_cvt_pk_bf16_f32 v17, v57, -v61
    v_cvt_pk_bf16_f32 v18, v58, -v62
    v_cvt_pk_bf16_f32 v19, v59, -v63
    v_xor_b32 v20, v48, v16
    v_xor_b32 v21, v48, v17
    v_xor_b32 v22, v48, v18
    v_xor_b32 v23, v48, v19
    ds_write_b128 v50, v[16:19] offset:20736
    ds_write_b128 v50, v[20:23] offset:21760
    v_and_b32 v48, 7, v2
    s_and_b32 s3, s34, 3
    s_lshl_b32 s3, s3, 4
    v_mul_u32_u24 v1, 288, v2
    v_lshl_add_u32 v1, v3, 4, v1
    v_lshrrev_b32 v50, 3, v2
    v_lshl_add_u32 v51, v50, 6, s3
    v_lshl_add_u32 v51, v3, 2, v51
    v_mul_u32_u24 v5, 2064, v48
    v_lshl_add_u32 v5, v51, 2, v5
    ds_read_b128 v[16:19], v4 offset:8448
    ds_read_b128 v[20:23], v4 offset:9472
    ds_read_b128 v[24:27], v4 offset:10496
    ds_read_b128 v[28:31], v4 offset:11520
    s_waitcnt vmcnt(0)
    s_branch L_Acommon
L_Awl:
    s_setprio 1
    s_barrier
    s_barrier
    s_bfe_u32 s45, s42, 0x10003
    s_sub_u32 s37, 8, s39
    s_and_b32 s37, s37, 7
    s_cmp_eq_u32 s45, 0
    s_cselect_b32 s37, s39, s37
    s_lshl_b32 s57, s53, 1
    s_add_u32 s57, s57, s58
    s_lshl_b32 s57, s57, 5
    s_lshl_b32 s53, s53, 7
    s_add_u32 s53, s53, 8523776
    s_lshl_b32 s58, s58, 3
    s_or_b32 s58, s58, s34
    s_mov_b32 s24, s70
    s_mov_b32 s25, s71
    s_mov_b32 s26, 1835008
    s_mov_b32 s27, 0x20000
    s_lshr_b32 s54, s34, 1
    s_mul_i32 s54, s54, 2080
    s_and_b32 s3, s34, 1
    s_lshl_b32 s38, s3, 10
    s_add_u32 s54, s54, s38
    s_lshr_b32 s55, s34, 2
    s_mul_i32 s55, s55, 4160
    s_lshl_b32 s38, s3, 11
    s_add_u32 s55, s55, s38
    s_lshl_b32 s38, s34, 9
    s_and_b32 s38, s38, 1024
    s_add_u32 s55, s55, s38
    s_add_u32 s55, s55, 71424
    s_add_u32 s40, s57, 0
    s_add_u32 s57, s57, 4259840
    s_and_b32 s3, s34, 5
    s_mov_b32 s51, 0x36124925
    s_cselect_b32 s50, s51, 0x35924925
    s_mov_b32 s51, s50
    s_lshl_b32 s52, s37, 5
    s_add_u32 s52, s52, s42
    s_mul_i32 s52, s52, 16640
    s_add_u32 s52, s52, 4259840
    s_mul_i32 s59, s34, 1152
    s_add_u32 s59, s59, 45568
    v_add_u32 v14, s55, v4
    v_add_u32 v10, s54, v4
    v_and_b32 v12, 1, v0
    v_mul_u32_u24 v15, 4160, v12
    v_lshrrev_b32 v11, 4, v0
    v_lshl_add_u32 v15, v11, 5, v15
    v_bfe_u32 v11, v0, 1, 1
    v_lshl_add_u32 v15, v11, 4, v15
    v_and_b32 v11, 12, v0
    v_add_u32 v11, 71424, v11
    v_add_u32 v15, v15, v11
    v_lshrrev_b32 v11, 1, v0
    v_mul_u32_u24 v13, 16640, v11
    v_lshl_add_u32 v13, v12, 4, v13
    v_lshlrev_b32 v11, 4, v0
    v_bfe_u32 v8, v0, 3, 4
    v_bfe_u32 v9, v0, 1, 2
    v_lshl_add_u32 v8, v9, 4, v8
    v_lshl_add_u32 v8, v8, 3, s37
    s_lshr_b32 s3, s42, 4
    s_mul_i32 s3, s3, 7
    s_and_b32 s38, s42, 15
    s_mul_i32 s38, s38, 28
    s_add_u32 s3, s3, s38
    s_sub_u32 s38, 445, s3
    s_cmp_eq_u32 s45, 0
    s_cselect_b32 s3, s3, s38
    s_cselect_b32 s38, 28, -28
    s_cselect_b32 s60, 1, -1
    s_mov_b32 s46, 0x05040100
    s_mov_b32 s47, 0x07060302
    s_cselect_b32 s48, s46, s47
    s_cselect_b32 s49, s47, s46
    s_cselect_b32 s56, 0, 0x80000000
    s_cselect_b32 s46, 0, 4160
    s_cselect_b32 s47, 4160, 0
    s_lshl_b32 s3, s3, 1
    v_mul_lo_u32 v9, v12, s38
    v_add_u32 v9, s3, v9
    s_movk_i32 s3, 450
    s_and_b32 s38, s39, 0
    s_lshl_b32 s38, s38, 9
    v_xor_b32 v8, s38, v8
    v_xor_b32 v45, 0x200, v8
    s_lshr_b32 s38, s38, 1
    v_mul_lo_u32 v8, v8, s60
    v_and_b32 v44, 2047, v8
    v_mad_u32_u24 v40, v44, s3, v9
    v_xor_b32 v44, 0x400, v44
    v_mad_u32_u24 v42, v44, s3, v9
    v_mul_lo_u32 v8, v45, s60
    v_and_b32 v44, 2047, v8
    v_mad_u32_u24 v41, v44, s3, v9
    v_xor_b32 v44, 0x400, v44
    v_mad_u32_u24 v43, v44, s3, v9
    v_mul_u32_u24 v8, 2080, v12
    v_lshlrev_b32 v9, 1, v0
    v_and_b32 v9, 0xfc, v9
    v_add_u32 v9, 37248, v9
    v_add3_u32 v36, v8, v9, s46
    v_add3_u32 v37, v8, v9, s47
    v_subrev_u32 v38, s38, v36
    v_subrev_u32 v39, s38, v37
    v_add_u32 v36, s38, v36
    v_add_u32 v37, s38, v37
    s_waitcnt lgkmcnt(0)
    s_mul_i32 s63, s32, 0x9e3779b1
    s_add_u32 s63, s63, 0x7f4a7c15
    s_mul_i32 s33, s63, 0x9e3779b1
    s_add_u32 s33, s33, 0x7f4a7c15
    s_and_b32 s32, s63, 0x803fffff
    s_or_b32 s32, s32, 0x7f810000
    s_and_b32 s33, s33, 0x803fffff
    s_or_b32 s33, s33, 0x7f810000
    s_setprio 2
    s_waitcnt vmcnt(0)
    s_barrier
    global_load_dwordx2 v[112:113], v40, s[64:65]
    global_load_dwordx2 v[114:115], v40, s[66:67]
    global_load_dwordx2 v[116:117], v41, s[64:65]
    global_load_dwordx2 v[118:119], v41, s[66:67]
    global_load_dwordx2 v[120:121], v42, s[64:65]
    global_load_dwordx2 v[122:123], v42, s[66:67]
    global_load_dwordx2 v[124:125], v43, s[64:65]
    global_load_dwordx2 v[126:127], v43, s[66:67]
    s_setprio 0
    v_cvt_f32_u32 v48, s36
    v_mul_f32 v48, 0x3a000000, v48
    v_cvt_f32_u32 v51, v3
    v_mul_f32 v9, v51, v48
    s_and_b32 s3, s34, 3
    v_lshl_add_u32 v50, s3, 4, v2
    v_cvt_f32_u32 v50, v50
    v_mul_f32 v8, 0x3b124925, v50
    v_add_f32 v53, v9, v8
    v_fmamk_f32 v54, v8, 0x40000000, v9
    v_fmamk_f32 v55, v8, 0x40400000, v9
    v_cos_f32 v96, v9
    v_sin_f32 v104, v9
    v_cos_f32 v97, v53
    v_sin_f32 v105, v53
    v_cos_f32 v98, v54
    v_sin_f32 v106, v54
    v_cos_f32 v99, v55
    v_sin_f32 v107, v55
    v_fmac_f32 v9, 4.0, v48
    v_add_f32 v53, v9, v8
    v_fmamk_f32 v54, v8, 0x40000000, v9
    v_fmamk_f32 v55, v8, 0x40400000, v9
    v_cos_f32 v100, v9
    v_sin_f32 v108, v9
    v_cos_f32 v101, v53
    v_sin_f32 v109, v53
    v_cos_f32 v102, v54
    v_sin_f32 v110, v54
    v_cos_f32 v103, v55
    v_sin_f32 v111, v55
    v_mul_f32 v50, 0x3c800000, v50
    v_mul_f32 v49, 0x41000000, v51
    v_mul_f32 v49, v49, v50
    v_and_b32 v48, 1, v2
    v_sub_u32 v48, 0, v48
    v_and_b32 v48, 0x80008000, v48
    v_fmamk_f32 v53, v50, 0x40000000, v49
    v_fmamk_f32 v54, v50, 0x40800000, v49
    v_fmamk_f32 v55, v50, 0x40c00000, v49
    v_cos_f32 v56, v49
    v_sin_f32 v60, v49
    v_cos_f32 v57, v53
    v_sin_f32 v61, v53
    v_cos_f32 v58, v54
    v_sin_f32 v62, v54
    v_cos_f32 v59, v55
    v_sin_f32 v63, v55
    v_cvt_pk_bf16_f32 v64, v56, -v60
    v_cvt_pk_bf16_f32 v80, v60, v56
    v_cvt_pk_bf16_f32 v65, v57, -v61
    v_cvt_pk_bf16_f32 v81, v61, v57
    v_cvt_pk_bf16_f32 v66, v58, -v62
    v_cvt_pk_bf16_f32 v82, v62, v58
    v_cvt_pk_bf16_f32 v67, v59, -v63
    v_cvt_pk_bf16_f32 v83, v63, v59
    v_xor_b32 v68, v48, v64
    v_xor_b32 v84, v48, v80
    v_xor_b32 v69, v48, v65
    v_xor_b32 v85, v48, v81
    v_xor_b32 v70, v48, v66
    v_xor_b32 v86, v48, v82
    v_xor_b32 v71, v48, v67
    v_xor_b32 v87, v48, v83
    v_add_f32 v52, v49, v50
    v_fmamk_f32 v53, v50, 0x40400000, v49
    v_fmamk_f32 v54, v50, 0x40a00000, v49
    v_fmamk_f32 v55, v50, 0x40e00000, v49
    v_cos_f32 v56, v52
    v_sin_f32 v60, v52
    v_cos_f32 v57, v53
    v_sin_f32 v61, v53
    v_cos_f32 v58, v54
    v_sin_f32 v62, v54
    v_cos_f32 v59, v55
    v_sin_f32 v63, v55
    v_cvt_pk_bf16_f32 v72, v56, -v60
    v_cvt_pk_bf16_f32 v88, v60, v56
    v_cvt_pk_bf16_f32 v73, v57, -v61
    v_cvt_pk_bf16_f32 v89, v61, v57
    v_cvt_pk_bf16_f32 v74, v58, -v62
    v_cvt_pk_bf16_f32 v90, v62, v58
    v_cvt_pk_bf16_f32 v75, v59, -v63
    v_cvt_pk_bf16_f32 v91, v63, v59
    v_xor_b32 v76, v48, v72
    v_xor_b32 v92, v48, v88
    v_xor_b32 v77, v48, v73
    v_xor_b32 v93, v48, v89
    v_xor_b32 v78, v48, v74
    v_xor_b32 v94, v48, v90
    v_xor_b32 v79, v48, v75
    v_xor_b32 v95, v48, v91
    v_and_b32 v48, 7, v2
    v_mul_u32_u24 v49, v48, v3
    v_cvt_f32_u32 v49, v49
    v_mul_f32 v49, 0x3e000000, v49
    v_and_b32 v48, 1, v2
    v_sub_u32 v48, 0, v48
    v_and_b32 v48, 0x80008000, v48
    s_and_b32 s3, s34, 3
    v_lshrrev_b32 v51, 3, v2
    v_lshl_add_u32 v51, s3, 1, v51
    v_cvt_f32_u32 v51, v51
    v_mul_f32 v51, 0x3e124925, v51
    v_lshl_add_u32 v50, s3, 11, v4
    v_add_f32 v53, v49, v51
    v_fmamk_f32 v54, v51, 0x40000000, v49
    v_fmamk_f32 v55, v51, 0x40400000, v49
    v_cos_f32 v56, v49
    v_sin_f32 v60, v49
    v_cos_f32 v57, v53
    v_sin_f32 v61, v53
    v_cos_f32 v58, v54
    v_sin_f32 v62, v54
    v_cos_f32 v59, v55
    v_sin_f32 v63, v55
    v_cvt_pk_bf16_f32 v16, v56, -v60
    v_cvt_pk_bf16_f32 v17, v57, -v61
    v_cvt_pk_bf16_f32 v18, v58, -v62
    v_cvt_pk_bf16_f32 v19, v59, -v63
    v_xor_b32 v20, v48, v16
    v_xor_b32 v21, v48, v17
    v_xor_b32 v22, v48, v18
    v_xor_b32 v23, v48, v19
    ds_write_b128 v50, v[16:19] offset:20736
    ds_write_b128 v50, v[20:23] offset:21760
    v_and_b32 v48, 7, v2
    s_and_b32 s3, s34, 3
    s_lshl_b32 s3, s3, 4
    v_mul_u32_u24 v1, 288, v2
    v_lshl_add_u32 v1, v3, 4, v1
    v_lshrrev_b32 v50, 3, v2
    v_lshl_add_u32 v51, v50, 6, s3
    v_lshl_add_u32 v51, v3, 2, v51
    v_mul_u32_u24 v5, 2064, v48
    v_lshl_add_u32 v5, v51, 2, v5
    s_setprio 2
    ds_read_b128 v[16:19], v4 offset:8448
    ds_read_b128 v[20:23], v4 offset:9472
    ds_read_b128 v[24:27], v4 offset:10496
    ds_read_b128 v[28:31], v4 offset:11520
    s_waitcnt vmcnt(6)
    v_perm_b32 v32, v114, v112, s48
    v_perm_b32 v33, v114, v112, s49
    v_xor_b32 v32, s56, v32
    v_xor_b32 v33, s56, v33
    ds_write2st64_b32 v36, v32, v33 offset0:0 offset1:4
    v_perm_b32 v34, v115, v113, s48
    v_perm_b32 v35, v115, v113, s49
    v_xor_b32 v34, s56, v34
    v_xor_b32 v35, s56, v35
    ds_write2st64_b32 v37, v34, v35 offset0:0 offset1:4
    s_waitcnt vmcnt(4)
    v_perm_b32 v32, v118, v116, s48
    v_perm_b32 v33, v118, v116, s49
    v_xor_b32 v32, s56, v32
    v_xor_b32 v33, s56, v33
    ds_write2st64_b32 v38, v32, v33 offset0:1 offset1:5
    v_perm_b32 v34, v119, v117, s48
    v_perm_b32 v35, v119, v117, s49
    v_xor_b32 v34, s56, v34
    v_xor_b32 v35, s56, v35
    ds_write2st64_b32 v39, v34, v35 offset0:1 offset1:5
    s_waitcnt vmcnt(2)
    v_perm_b32 v32, v122, v120, s48
    v_perm_b32 v33, v122, v120, s49
    v_xor_b32 v32, s56, v32
    v_xor_b32 v33, s56, v33
    ds_write2st64_b32 v36, v32, v33 offset0:2 offset1:6
    v_perm_b32 v34, v123, v121, s48
    v_perm_b32 v35, v123, v121, s49
    v_xor_b32 v34, s56, v34
    v_xor_b32 v35, s56, v35
    ds_write2st64_b32 v37, v34, v35 offset0:2 offset1:6
    s_waitcnt vmcnt(0)
    v_perm_b32 v32, v126, v124, s48
    v_perm_b32 v33, v126, v124, s49
    v_xor_b32 v32, s56, v32
    v_xor_b32 v33, s56, v33
    ds_write2st64_b32 v38, v32, v33 offset0:3 offset1:7
    v_perm_b32 v34, v127, v125, s48
    v_perm_b32 v35, v127, v125, s49
    v_xor_b32 v34, s56, v34
    v_xor_b32 v35, s56, v35
    ds_write2st64_b32 v39, v34, v35 offset0:3 offset1:7
L_Acommon:
    s_setprio 2
    s_waitcnt lgkmcnt(0)
    s_barrier
    ds_read_b128 v[48:51], v10 offset:28928
    ds_read_b128 v[60:63], v10 offset:37248
    v_mov_b32 v124, 0
    s_cmp_lt_u32 s58, 8
    s_cbranch_scc1 L_nofl
    buffer_load_dwordx2 v[122:123], v124, s[28:31], s53 offen sc1
L_nofl:
    s_waitcnt lgkmcnt(1)
    v_mfma_f32_16x16x32_bf16 v[52:55], v[48:51], v[16:19], 0
    v_mfma_f32_16x16x32_bf16 v[56:59], v[48:51], v[20:23], 0
    s_waitcnt lgkmcnt(0)
    v_lshlrev_b32 v32, 16, v60
    v_and_b32 v36, 0xffff0000, v60
    v_lshlrev_b32 v33, 16, v61
    v_and_b32 v37, 0xffff0000, v61
    v_lshlrev_b32 v34, 16, v62
    v_and_b32 v38, 0xffff0000, v62
    v_lshlrev_b32 v35, 16, v63
    v_and_b32 v39, 0xffff0000, v63
    v_pk_mul_f32 v[40:41], v[52:53], v[24:25]
    v_pk_mul_f32 v[42:43], v[52:53], v[28:29]
    v_pk_mul_f32 v[44:45], v[54:55], v[26:27]
    v_pk_mul_f32 v[46:47], v[54:55], v[30:31]
    v_pk_fma_f32 v[52:53], v[56:57], v[28:29], v[40:41] neg_lo:[1,0,0] neg_hi:[1,0,0]
    v_pk_fma_f32 v[56:57], v[56:57], v[24:25], v[42:43]
    v_pk_fma_f32 v[54:55], v[58:59], v[30:31], v[44:45] neg_lo:[1,0,0] neg_hi:[1,0,0]
    v_pk_fma_f32 v[58:59], v[58:59], v[26:27], v[46:47]
    v_cvt_pk_bf16_f32 v48, v52, v56
    v_cvt_pk_bf16_f32 v49, v53, v57
    v_cvt_pk_bf16_f32 v50, v54, v58
    v_cvt_pk_bf16_f32 v51, v55, v59
    s_nop 1
    v_mfma_f32_16x16x32_bf16 v[52:55], v[16:19], v[48:51], 0
    v_mfma_f32_16x16x32_bf16 v[56:59], v[20:23], v[48:51], 0
    v_pk_mul_f32 v[32:33], v[32:33], s[50:51]
    v_pk_mul_f32 v[34:35], v[34:35], s[50:51]
    v_pk_mul_f32 v[36:37], v[36:37], s[50:51]
    v_pk_mul_f32 v[38:39], v[38:39], s[50:51]
    s_nop 2
    v_pk_mul_f32 v[40:41], v[52:53], v[32:33]
    v_pk_mul_f32 v[42:43], v[52:53], v[36:37]
    v_pk_mul_f32 v[44:45], v[54:55], v[34:35]
    v_pk_mul_f32 v[46:47], v[54:55], v[38:39]
    v_pk_fma_f32 v[52:53], v[56:57], v[36:37], v[40:41] neg_lo:[1,0,0] neg_hi:[1,0,0]
    v_pk_fma_f32 v[56:57], v[56:57], v[32:33], v[42:43]
    v_pk_fma_f32 v[54:55], v[58:59], v[38:39], v[44:45] neg_lo:[1,0,0] neg_hi:[1,0,0]
    v_pk_fma_f32 v[58:59], v[58:59], v[34:35], v[46:47]
    v_cvt_pk_bf16_f32 v48, v56, v52
    v_cvt_pk_bf16_f32 v49, v57, v53
    v_cvt_pk_bf16_f32 v50, v58, v54
    v_cvt_pk_bf16_f32 v51, v59, v55
    s_nop 1
    v_mfma_f32_16x16x32_bf16 v[52:55], v[48:51], v[20:23], 0
    v_mfma_f32_16x16x32_bf16 v[56:59], v[48:51], v[16:19], 0
    v_and_b32 v9, 1, v0
    v_mul_u32_u24 v9, 576, v9
    v_bfe_u32 v12, v0, 1, 5
    v_lshl_add_u32 v9, v12, 3, v9
    v_add_u32 v9, s59, v9
    s_nop 1
    v_pk_mul_f32 v[40:41], v[52:53], v[24:25]
    v_pk_mul_f32 v[42:43], v[52:53], v[28:29]
    v_pk_mul_f32 v[44:45], v[54:55], v[26:27]
    v_pk_mul_f32 v[46:47], v[54:55], v[30:31]
    v_pk_fma_f32 v[52:53], v[56:57], v[28:29], v[40:41]
    v_pk_fma_f32 v[56:57], v[56:57], v[24:25], v[42:43] neg_lo:[0,0,1] neg_hi:[0,0,1]
    v_pk_fma_f32 v[54:55], v[58:59], v[30:31], v[44:45]
    v_pk_fma_f32 v[58:59], v[58:59], v[26:27], v[46:47] neg_lo:[0,0,1] neg_hi:[0,0,1]
    v_cvt_pk_bf16_f32 v48, v56, v52
    v_cvt_pk_bf16_f32 v49, v57, v53
    v_cvt_pk_bf16_f32 v50, v58, v54
    v_cvt_pk_bf16_f32 v51, v59, v55
    s_nop 1
    v_mfma_f32_16x16x32_bf16 v[52:55], v[20:23], v[48:51], 0
    v_mfma_f32_16x16x32_bf16 v[56:59], v[16:19], v[48:51], 0
    s_nop 7
    v_cvt_pk_bf16_f32 v48, v52, v56
    v_cvt_pk_bf16_f32 v49, v53, v57
    v_cvt_pk_bf16_f32 v50, v54, v58
    v_cvt_pk_bf16_f32 v51, v55, v59
    ds_write_b128 v14, v[48:51]
    s_waitcnt lgkmcnt(0)
    s_barrier
    ds_read2st64_b32 v[112:113], v15 offset0:0 offset1:4
    ds_read2st64_b32 v[114:115], v15 offset0:8 offset1:12
    s_waitcnt lgkmcnt(0)
    buffer_store_dwordx4 v[112:115], v11, s[28:31], s52 offen sc1
    s_cmp_ge_u32 s34, 4
    s_cbranch_scc0 L_Af2
    ds_read_b128 v[16:19], v4 offset:20736
    ds_read_b128 v[20:23], v4 offset:21760
    ds_read_b128 v[24:27], v4 offset:22784
    ds_read_b128 v[28:31], v4 offset:23808
    ds_read_b128 v[32:35], v4 offset:24832
    ds_read_b128 v[36:39], v4 offset:25856
    ds_read_b128 v[40:43], v4 offset:26880
    ds_read_b128 v[44:47], v4 offset:27904
    s_cmp_lg_u32 s34, 5
    s_cbranch_scc1 L_nosig
    v_and_b32 v48, 7, v0
    v_lshlrev_b32 v49, 2, v48
    ds_read_b32 v52, v49 offset:54784
    ds_read_b32 v53, v49 offset:54816
    s_waitcnt lgkmcnt(0)
    v_add_f32 v52, v52, v53
    v_cvt_pk_bf16_f32 v52, v52, v52
    v_lshlrev_b32 v52, 16, v52
    v_mul_f32 v52, 0xbfb8aa3b, v52
    v_exp_f32 v52, v52
    s_nop 0
    v_add_f32 v52, 1.0, v52
    v_rcp_f32 v52, v52
    s_nop 0
    v_cvt_pk_bf16_f32 v52, v52, v52
    v_lshlrev_b32 v52, 16, v52
    v_sub_f32 v53, 1.0, v52
    v_cvt_pk_bf16_f32 v53, v53, v53
    v_lshlrev_b32 v53, 16, v53
    ds_write_b32 v49, v52 offset:54848
    ds_write_b32 v49, v53 offset:54880
L_nosig:
    s_cmp_lt_u32 s58, 8
    s_cbranch_scc1 Lzg_if_ok
Lzg_if:
    s_waitcnt vmcnt(0)
    v_xor_b32 v12, s32, v122
    v_bitop3_b32 v12, v123, s33, v12 bitop3:0xbe
    v_cmp_ne_u32 vcc, 0, v12
    s_cmp_eq_u64 vcc, 0
    s_cbranch_scc1 Lzg_if_ok
    s_sleep 2
    s_add_u32 s62, s62, 1
    s_cmp_gt_u32 s62, 400000
    s_cbranch_scc1 Lzg_if_ok
    buffer_load_dwordx2 v[122:123], v124, s[28:31], s53 offen sc1
    s_branch Lzg_if
Lzg_if_ok:
    s_mov_b32 exec_lo, 268435456
    s_mov_b32 exec_hi, 268435456
    buffer_load_dwordx4 v[116:119], v13, s[28:31], s57 offen sc1
    s_mov_b64 exec, -1
    s_mov_b32 exec_lo, 268435456
    s_mov_b32 exec_hi, 268435456
    s_branch Lzg_is_c
Lzg_is:
    s_sleep 1
    s_add_u32 s62, s62, 1
    s_cmp_gt_u32 s62, 400000
    s_cbranch_scc1 Lzg_is_ok
Lzg_is_s:
    buffer_load_dwordx4 v[116:119], v13, s[28:31], s57 offen sc1
Lzg_is_c:
    s_waitcnt vmcnt(0)
    v_cmp_eq_u32 vcc, s32, v117
    v_cmp_eq_u32 s[60:61], s33, v119
    s_or_b64 vcc, vcc, s[60:61]
    s_cbranch_scc1 Lzg_is
Lzg_is_ok:
    s_mov_b64 exec, -1
    buffer_load_dwordx4 v[116:119], v13, s[28:31], s57 offen sc1
Lzg_i:
    s_waitcnt vmcnt(0)
    v_cmp_eq_u32 vcc, s32, v117
    v_cmp_eq_u32 s[60:61], s33, v119
    s_or_b64 vcc, vcc, s[60:61]
    s_cbranch_scc0 Lzg_i_ok
    s_mov_b64 exec, vcc
    s_sleep 1
    s_add_u32 s62, s62, 1
    s_cmp_gt_u32 s62, 400000
    s_cbranch_scc1 Lzg_i_ok
    buffer_load_dwordx4 v[116:119], v13, s[28:31], s57 offen sc1
    s_branch Lzg_i
Lzg_i_ok:
    s_mov_b64 exec, -1
    ds_write2_b64 v9, v[116:117], v[118:119] offset0:0 offset1:36
    s_waitcnt lgkmcnt(0)
    s_barrier
    ds_read_b128 v[48:51], v1 offset:45568
    ds_read_b128 v[52:55], v1 offset:45632
    ds_read_b128 v[56:59], v1 offset:45696
    ds_read_b128 v[60:63], v1 offset:45760
    ds_read_b128 v[112:115], v1 offset:50176
    ds_read_b128 v[116:119], v1 offset:50240
    ds_read_b128 v[120:123], v1 offset:50304
    ds_read_b128 v[124:127], v1 offset:50368
    s_waitcnt lgkmcnt(7)
    v_mfma_f32_16x16x32_bf16 v[8:11], v[48:51], v[64:67], 0
    v_mfma_f32_16x16x32_bf16 v[12:15], v[48:51], v[80:83], 0
    s_waitcnt lgkmcnt(6)
    v_mfma_f32_16x16x32_bf16 v[8:11], v[52:55], v[68:71], v[8:11]
    v_mfma_f32_16x16x32_bf16 v[12:15], v[52:55], v[84:87], v[12:15]
    s_waitcnt lgkmcnt(5)
    v_mfma_f32_16x16x32_bf16 v[8:11], v[56:59], v[72:75], v[8:11]
    v_mfma_f32_16x16x32_bf16 v[12:15], v[56:59], v[88:91], v[12:15]
    s_waitcnt lgkmcnt(4)
    v_mfma_f32_16x16x32_bf16 v[8:11], v[60:63], v[76:79], v[8:11]
    v_mfma_f32_16x16x32_bf16 v[12:15], v[60:63], v[92:95], v[12:15]
    s_waitcnt lgkmcnt(3)
    v_mfma_f32_16x16x32_bf16 v[48:51], v[112:115], v[64:67], 0
    v_mfma_f32_16x16x32_bf16 v[52:55], v[112:115], v[80:83], 0
    s_waitcnt lgkmcnt(2)
    v_mfma_f32_16x16x32_bf16 v[48:51], v[116:119], v[68:71], v[48:51]
    v_mfma_f32_16x16x32_bf16 v[52:55], v[116:119], v[84:87], v[52:55]
    s_waitcnt lgkmcnt(1)
    v_mfma_f32_16x16x32_bf16 v[48:51], v[120:123], v[72:75], v[48:51]
    v_mfma_f32_16x16x32_bf16 v[52:55], v[120:123], v[88:91], v[52:55]
    s_waitcnt lgkmcnt(0)
    v_mfma_f32_16x16x32_bf16 v[48:51], v[124:127], v[76:79], v[48:51]
    v_mfma_f32_16x16x32_bf16 v[52:55], v[124:127], v[92:95], v[52:55]
    v_pk_mul_f32 v[56:57], v[8:9], v[96:97]
    v_pk_mul_f32 v[58:59], v[8:9], v[104:105]
    v_pk_mul_f32 v[60:61], v[10:11], v[98:99]
    v_pk_mul_f32 v[62:63], v[10:11], v[106:107]
    v_pk_fma_f32 v[8:9], v[12:13], v[104:105], v[56:57] neg_lo:[1,0,0] neg_hi:[1,0,0]
    v_pk_fma_f32 v[12:13], v[12:13], v[96:97], v[58:59]
    v_pk_fma_f32 v[10:11], v[14:15], v[106:107], v[60:61] neg_lo:[1,0,0] neg_hi:[1,0,0]
    v_pk_fma_f32 v[14:15], v[14:15], v[98:99], v[62:63]
    v_cvt_pk_bf16_f32 v112, v8, v12
    v_cvt_pk_bf16_f32 v113, v9, v13
    v_cvt_pk_bf16_f32 v114, v10, v14
    v_cvt_pk_bf16_f32 v115, v11, v15
    s_nop 1
    v_mfma_f32_16x16x32_bf16 v[64:67], v[112:115], v[16:19], 0
    v_mfma_f32_16x16x32_bf16 v[68:71], v[112:115], v[24:27], 0
    v_mfma_f32_16x16x32_bf16 v[72:75], v[112:115], v[32:35], 0
    v_mfma_f32_16x16x32_bf16 v[76:79], v[112:115], v[40:43], 0
    v_pk_mul_f32 v[56:57], v[48:49], v[100:101]
    v_pk_mul_f32 v[58:59], v[48:49], v[108:109]
    v_pk_mul_f32 v[60:61], v[50:51], v[102:103]
    v_pk_mul_f32 v[62:63], v[50:51], v[110:111]
    v_pk_fma_f32 v[48:49], v[52:53], v[108:109], v[56:57] neg_lo:[1,0,0] neg_hi:[1,0,0]
    v_pk_fma_f32 v[52:53], v[52:53], v[100:101], v[58:59]
    v_pk_fma_f32 v[50:51], v[54:55], v[110:111], v[60:61] neg_lo:[1,0,0] neg_hi:[1,0,0]
    v_pk_fma_f32 v[54:55], v[54:55], v[102:103], v[62:63]
    v_cvt_pk_bf16_f32 v116, v48, v52
    v_cvt_pk_bf16_f32 v117, v49, v53
    v_cvt_pk_bf16_f32 v118, v50, v54
    v_cvt_pk_bf16_f32 v119, v51, v55
    s_nop 1
    v_mfma_f32_16x16x32_bf16 v[64:67], v[116:119], v[20:23], v[64:67]
    v_mfma_f32_16x16x32_bf16 v[68:71], v[116:119], v[28:31], v[68:71]
    v_mfma_f32_16x16x32_bf16 v[72:75], v[116:119], v[36:39], v[72:75]
    v_mfma_f32_16x16x32_bf16 v[76:79], v[116:119], v[44:47], v[76:79]
    s_nop 4
    ds_write_b128 v5, v[64:67] offset:54912
    ds_write_b128 v5, v[68:71] offset:55424
    ds_write_b128 v5, v[72:75] offset:55936
    ds_write_b128 v5, v[76:79] offset:56448
    s_waitcnt lgkmcnt(0)
    s_barrier
    s_endpgm
L_Af2:
    s_cmp_lt_u32 s58, 8
    s_cbranch_scc1 Lzg_ff_ok
Lzg_ff:
    s_waitcnt vmcnt(0)
    v_xor_b32 v12, s32, v122
    v_bitop3_b32 v12, v123, s33, v12 bitop3:0xbe
    v_cmp_ne_u32 vcc, 0, v12
    s_cmp_eq_u64 vcc, 0
    s_cbranch_scc1 Lzg_ff_ok
    s_sleep 2
    s_add_u32 s62, s62, 1
    s_cmp_gt_u32 s62, 400000
    s_cbranch_scc1 Lzg_ff_ok
    buffer_load_dwordx2 v[122:123], v124, s[28:31], s53 offen sc1
    s_branch Lzg_ff
Lzg_ff_ok:
    s_mov_b32 exec_lo, 268435456
    s_mov_b32 exec_hi, 268435456
    buffer_load_dwordx4 v[116:119], v13, s[28:31], s57 offen sc1
    s_mov_b64 exec, -1
    s_mov_b32 exec_lo, 268435456
    s_mov_b32 exec_hi, 268435456
    s_branch Lzg_fs_c
Lzg_fs:
    s_sleep 1
    s_add_u32 s62, s62, 1
    s_cmp_gt_u32 s62, 400000
    s_cbranch_scc1 Lzg_fs_ok
Lzg_fs_s:
    buffer_load_dwordx4 v[116:119], v13, s[28:31], s57 offen sc1
Lzg_fs_c:
    s_waitcnt vmcnt(0)
    v_cmp_eq_u32 vcc, s32, v117
    v_cmp_eq_u32 s[60:61], s33, v119
    s_or_b64 vcc, vcc, s[60:61]
    s_cbranch_scc1 Lzg_fs
Lzg_fs_ok:
    s_mov_b64 exec, -1
    buffer_load_dwordx4 v[116:119], v13, s[28:31], s57 offen sc1
Lzg_f:
    s_waitcnt vmcnt(0)
    v_cmp_eq_u32 vcc, s32, v117
    v_cmp_eq_u32 s[60:61], s33, v119
    s_or_b64 vcc, vcc, s[60:61]
    s_cbranch_scc0 Lzg_f_ok
    s_mov_b64 exec, vcc
    s_sleep 1
    s_add_u32 s62, s62, 1
    s_cmp_gt_u32 s62, 400000
    s_cbranch_scc1 Lzg_f_ok
    buffer_load_dwordx4 v[116:119], v13, s[28:31], s57 offen sc1
    s_branch Lzg_f
Lzg_f_ok:
    s_mov_b64 exec, -1
    ds_write2_b64 v9, v[116:117], v[118:119] offset0:0 offset1:36
    s_mov_b32 exec_lo, 268435456
    s_mov_b32 exec_hi, 268435456
    buffer_load_dwordx4 v[64:67], v76, s[28:31], s40 offen sc1
    buffer_load_dwordx4 v[68:71], v77, s[28:31], s41 offen sc1
    s_mov_b64 exec, -1
    s_waitcnt lgkmcnt(0)
    s_barrier
    ds_read_b128 v[72:75], v81 offset:54880
    ds_read_b128 v[84:87], v81 offset:54848
    s_waitcnt lgkmcnt(0)
    v_mul_f32 v96, v96, v72
    v_mul_f32 v97, v97, v72
    v_mul_f32 v98, v98, v73
    v_mul_f32 v99, v99, v73
    v_mul_f32 v100, v100, v74
    v_mul_f32 v101, v101, v74
    v_mul_f32 v102, v102, v75
    v_mul_f32 v103, v103, v75
    v_mul_f32 v104, v104, v72
    v_mul_f32 v105, v105, v72
    v_mul_f32 v106, v106, v73
    v_mul_f32 v107, v107, v73
    v_mul_f32 v108, v108, v74
    v_mul_f32 v109, v109, v74
    v_mul_f32 v110, v110, v75
    v_mul_f32 v111, v111, v75
    s_mov_b32 exec_lo, 268435456
    s_mov_b32 exec_hi, 268435456
    s_branch Lbs_c
Lbs:
    s_sleep 1
    s_add_u32 s62, s62, 1
    s_cmp_gt_u32 s62, 400000
    s_cbranch_scc1 Lbs_ok
Lbs_s:
    buffer_load_dwordx4 v[64:67], v76, s[28:31], s40 offen sc1
    buffer_load_dwordx4 v[68:71], v77, s[28:31], s41 offen sc1
Lbs_c:
    s_waitcnt vmcnt(0)
    v_cmp_eq_u32 vcc, s32, v65
    v_cmp_eq_u32 s[60:61], s33, v67
    s_or_b64 vcc, vcc, s[60:61]
    v_cmp_eq_u32 s[60:61], s32, v69
    s_or_b64 vcc, vcc, s[60:61]
    v_cmp_eq_u32 s[60:61], s33, v71
    s_or_b64 vcc, vcc, s[60:61]
    s_cbranch_scc1 Lbs
Lbs_ok:
    s_mov_b64 exec, -1
    buffer_load_dwordx4 v[64:67], v76, s[28:31], s40 offen sc1
    buffer_load_dwordx4 v[68:71], v77, s[28:31], s41 offen sc1
    s_barrier
    ds_read_b64 v[16:17], v78 offset:0
    ds_read_b64 v[18:19], v78 offset:2064
    ds_read_b64 v[20:21], v78 offset:4128
    ds_read_b64 v[22:23], v78 offset:6192
    ds_read_b64 v[24:25], v78 offset:1024
    ds_read_b64 v[26:27], v78 offset:3088
    ds_read_b64 v[28:29], v78 offset:5152
    ds_read_b64 v[30:31], v78 offset:7216
    s_waitcnt lgkmcnt(7)
    v_fmac_f32 v96, v16, v84
    v_fmac_f32 v97, v17, v84
    s_waitcnt lgkmcnt(6)
    v_fmac_f32 v98, v18, v85
    v_fmac_f32 v99, v19, v85
    s_waitcnt lgkmcnt(5)
    v_fmac_f32 v100, v20, v86
    v_fmac_f32 v101, v21, v86
    s_waitcnt lgkmcnt(4)
    v_fmac_f32 v102, v22, v87
    v_fmac_f32 v103, v23, v87
    s_waitcnt lgkmcnt(3)
    v_fmac_f32 v104, v24, v84
    v_fmac_f32 v105, v25, v84
    s_waitcnt lgkmcnt(2)
    v_fmac_f32 v106, v26, v85
    v_fmac_f32 v107, v27, v85
    s_waitcnt lgkmcnt(1)
    v_fmac_f32 v108, v28, v86
    v_fmac_f32 v109, v29, v86
    s_waitcnt lgkmcnt(0)
    v_fmac_f32 v110, v30, v87
    v_fmac_f32 v111, v31, v87
Lbg:
    s_waitcnt vmcnt(0)
    v_cmp_eq_u32 vcc, s32, v65
    v_cmp_eq_u32 s[60:61], s33, v67
    s_or_b64 vcc, vcc, s[60:61]
    v_cmp_eq_u32 s[60:61], s32, v69
    s_or_b64 vcc, vcc, s[60:61]
    v_cmp_eq_u32 s[60:61], s33, v71
    s_or_b64 vcc, vcc, s[60:61]
    s_cbranch_scc0 Lbg_ok
    s_mov_b64 exec, vcc
    s_sleep 1
    s_add_u32 s62, s62, 1
    s_cmp_gt_u32 s62, 400000
    s_cbranch_scc1 Lbg_ok
    buffer_load_dwordx4 v[64:67], v76, s[28:31], s40 offen sc1
    buffer_load_dwordx4 v[68:71], v77, s[28:31], s41 offen sc1
    s_branch Lbg
Lbg_ok:
    s_mov_b64 exec, -1
    v_lshlrev_b32 v48, 16, v64
    v_lshlrev_b32 v49, 16, v65
    v_fmac_f32 v96, v48, v72
    v_fmac_f32 v97, v49, v72
    v_and_b32 v50, 0xffff0000, v64
    v_cvt_pk_bf16_f32 v48, v96, v97
    v_and_b32 v51, 0xffff0000, v65
    buffer_store_dword v48, v79, s[24:27], s44 offen offset:0
    v_fmac_f32 v98, v50, v73
    v_fmac_f32 v99, v51, v73
    v_cvt_pk_bf16_f32 v49, v98, v99
    buffer_store_dword v49, v79, s[24:27], s45 offen offset:0
    v_lshlrev_b32 v52, 16, v66
    v_lshlrev_b32 v53, 16, v67
    v_fmac_f32 v100, v52, v74
    v_fmac_f32 v101, v53, v74
    v_and_b32 v54, 0xffff0000, v66
    v_cvt_pk_bf16_f32 v52, v100, v101
    v_and_b32 v55, 0xffff0000, v67
    buffer_store_dword v52, v79, s[24:27], s46 offen offset:0
    v_fmac_f32 v102, v54, v75
    v_fmac_f32 v103, v55, v75
    v_cvt_pk_bf16_f32 v53, v102, v103
    buffer_store_dword v53, v79, s[24:27], s43 offen offset:0
    v_lshlrev_b32 v56, 16, v68
    v_lshlrev_b32 v57, 16, v69
    v_fmac_f32 v104, v56, v72
    v_fmac_f32 v105, v57, v72
    v_and_b32 v58, 0xffff0000, v68
    v_cvt_pk_bf16_f32 v56, v104, v105
    v_and_b32 v59, 0xffff0000, v69
    buffer_store_dword v56, v80, s[24:27], s44 offen offset:512
    v_fmac_f32 v106, v58, v73
    v_fmac_f32 v107, v59, v73
    v_cvt_pk_bf16_f32 v57, v106, v107
    buffer_store_dword v57, v80, s[24:27], s45 offen offset:512
    v_lshlrev_b32 v60, 16, v70
    v_lshlrev_b32 v61, 16, v71
    v_fmac_f32 v108, v60, v74
    v_fmac_f32 v109, v61, v74
    v_and_b32 v62, 0xffff0000, v70
    v_cvt_pk_bf16_f32 v60, v108, v109
    v_and_b32 v63, 0xffff0000, v71
    buffer_store_dword v60, v80, s[24:27], s46 offen offset:512
    v_fmac_f32 v110, v62, v75
    v_fmac_f32 v111, v63, v75
    v_cvt_pk_bf16_f32 v61, v110, v111
    buffer_store_dword v61, v80, s[24:27], s43 offen offset:512
    s_barrier
    s_cmp_lg_u32 s35, 0
    s_cbranch_scc1 L_noep
    s_cmp_lg_u32 s34, 0
    s_cbranch_scc1 L_noep
    v_mov_b32 v48, s63
    v_mov_b32 v49, 8519680
    s_mov_b64 exec, 1
    buffer_store_dword v48, v49, s[28:31], 0 offen sc1
    s_mov_b64 exec, -1
L_noep:
    s_endpgm
L_B:
    s_setprio 3
    s_lshr_b32 s36, s34, 2
    s_sub_u32 s38, 3, s37
    s_cmp_eq_u32 s36, 0
    s_cselect_b32 s38, s37, s38
    s_cmp_ge_u32 s38, 2
    s_cbranch_scc1 L_noband
    v_lshrrev_b32 v46, 1, v0
    v_and_b32 v46, 24, v46
    s_movk_i32 s51, 56
    v_lshlrev_b32 v47, v42, s51
    v_bfe_u32 v47, v47, v46, 8
    v_lshl_or_b32 v47, v47, 15, v47
    v_and_b32 v120, 65537, v47
    v_and_b32 v121, 262148, v47
    v_and_b32 v122, 1048592, v47
    v_and_b32 v123, 4194368, v47
    v_mul_u32_u24 v120, 16256, v120
    v_mul_u32_u24 v121, 4064, v121
    v_mul_u32_u24 v122, 1016, v122
    v_mul_u32_u24 v123, 254, v123
    s_movk_i32 s51, 124
    v_lshlrev_b32 v47, v42, s51
    v_bfe_u32 v47, v47, v46, 8
    v_lshl_or_b32 v47, v47, 15, v47
    v_and_b32 v124, 65537, v47
    v_and_b32 v125, 262148, v47
    v_and_b32 v126, 1048592, v47
    v_and_b32 v127, 4194368, v47
    v_mul_u32_u24 v124, 16256, v124
    v_mul_u32_u24 v125, 4064, v125
    v_mul_u32_u24 v126, 1016, v126
    v_mul_u32_u24 v127, 254, v127
    s_cmp_eq_u32 s38, 1
    s_cbranch_scc1 L_noband
    s_movk_i32 s51, 254
    v_lshlrev_b32 v47, v42, s51
    v_bfe_u32 v47, v47, v46, 8
    v_lshl_or_b32 v47, v47, 15, v47
    v_and_b32 v112, 65537, v47
    v_and_b32 v113, 262148, v47
    v_and_b32 v114, 1048592, v47
    v_and_b32 v115, 4194368, v47
    v_mul_u32_u24 v112, 16256, v112
    v_mul_u32_u24 v113, 4064, v113
    v_mul_u32_u24 v114, 1016, v114
    v_mul_u32_u24 v115, 254, v115
    s_movk_i32 s51, 511
    v_lshlrev_b32 v47, v42, s51
    v_bfe_u32 v47, v47, v46, 8
    v_lshl_or_b32 v47, v47, 15, v47
    v_and_b32 v116, 65537, v47
    v_and_b32 v117, 262148, v47
    v_and_b32 v118, 1048592, v47
    v_and_b32 v119, 4194368, v47
    v_mul_u32_u24 v116, 16256, v116
    v_mul_u32_u24 v117, 4064, v117
    v_mul_u32_u24 v118, 1016, v118
    v_mul_u32_u24 v119, 254, v119
L_noband:
    s_mul_i32 s39, s34, 8704
    s_mov_b32 m0, s39
    s_mul_i32 s49, s36, 34816
    s_mul_i32 s50, s36, 4624
    s_lshl_b32 s52, s36, 9
    s_mul_i32 s53, s36, 320
    s_and_b32 s3, s34, 1
    s_lshr_b32 s40, s34, 1
    s_lshl_b32 s41, s3, 4
    s_lshl_b32 s42, s40, 7
    s_add_u32 s41, s41, s42
    s_lshl_b32 s42, s3, 9
    s_lshl_b32 s43, s40, 6
    s_add_u32 s42, s42, s43
    s_mul_i32 s43, s38, 8704
    s_lshr_b32 s44, s38, 1
    s_lshl_b32 s44, s44, 6
    s_add_u32 s43, s43, s44
    s_add_u32 s43, s43, s49
    s_add_u32 s43, s43, 3200
    s_lshl_b32 s44, s34, 10
    s_lshl_b32 s45, s3, 10
    s_add_u32 s45, s45, 78880
    s_cmp_eq_u32 s37, 3
    s_cselect_b32 s46, s52, 0
    s_cselect_b32 s47, s53, 0
    s_mul_i32 s54, s35, 16640
    s_add_u32 s54, s54, 0
    s_add_u32 s55, s54, 8192
    s_lshl_b32 s56, s37, 3
    s_lshr_b32 s56, 0x00300080, s56
    s_and_b32 s56, s56, 0xff
    s_add_u32 s56, s56, s39
    s_add_u32 s56, s56, 4608
    v_mov_b32 v48, 0
    v_mov_b32 v49, 0
    v_mov_b32 v50, 0
    v_mov_b32 v51, 0
    s_waitcnt lgkmcnt(0)
    s_mul_i32 s63, s32, 0x9e3779b1
    s_add_u32 s63, s63, 0x7f4a7c15
    s_mul_i32 s33, s63, 0x9e3779b1
    s_add_u32 s33, s33, 0x7f4a7c15
    s_and_b32 s32, s63, 0x803fffff
    s_or_b32 s32, s32, 0x7f810000
    s_and_b32 s33, s33, 0x803fffff
    s_or_b32 s33, s33, 0x7f810000
    s_lshl_b32 s3, s48, 16
    s_and_b32 s40, s48, 0xffff0000
    s_cmp_eq_u32 s36, 0
    s_cselect_b32 s48, s3, s40
    v_mov_b32 v44, 0x3fb8aa3b
    v_mul_f32 v45, s48, v44
    v_exp_f32 v45, v45
    v_add_u32 v1, s45, v22
    ds_write_b128 v1, v[48:51]
    v_add_u32 v1, 69632, v22
    v_cvt_pk_bf16_f32 v45, v45, v45
    v_lshlrev_b32 v46, 16, v45
    v_mul_f32 v44, v44, v46
    v_mul_f32 v45, 0.15915494, v46
    s_waitcnt vmcnt(3)
    s_setprio 1
    v_pk_mul_f32 v[24:25], v[24:25], v[44:45]
    v_pk_mul_f32 v[36:37], v[28:29], v[26:27] op_sel:[0,0] op_sel_hi:[0,1]
    v_pk_fma_f32 v[36:37], v[28:29], v[26:27], v[36:37] op_sel:[1,1,0] op_sel_hi:[1,0,1] neg_lo:[0,1,0]
    v_fract_f32 v39, v25
    v_exp_f32 v38, v24
    v_cos_f32 v30, v39
    v_sin_f32 v31, v39
    v_mul_f32 v40, 0x43800000, v24
    v_mul_f32 v41, 0x43800000, v25
    v_fract_f32 v41, v41
    v_exp_f32 v40, v40
    v_cos_f32 v34, v41
    v_sin_f32 v35, v41
    v_mul_f32 v42, 0x41000000, v24
    v_mul_f32 v43, 0x41000000, v25
    v_fract_f32 v43, v43
    v_exp_f32 v42, v42
    v_cos_f32 v32, v43
    v_sin_f32 v33, v43
    v_pk_mul_f32 v[36:37], v[36:37], v[46:47] op_sel_hi:[1,0]
    v_pk_mul_f32 v[30:31], v[30:31], v[38:39] op_sel_hi:[1,0]
    v_pk_mul_f32 v[34:35], v[34:35], v[40:41] op_sel_hi:[1,0]
    v_pk_mul_f32 v[32:33], v[32:33], v[42:43] op_sel_hi:[1,0]
    v_cvt_pk_bf16_f32 v44, v36, -v37
    ds_write_addtid_b32 v44 offset:0
    v_pk_mul_f32 v[24:25], v[36:37], v[34:35] op_sel:[0,0] op_sel_hi:[0,1]
    v_pk_fma_f32 v[24:25], v[36:37], v[34:35], v[24:25] op_sel:[1,1,0] op_sel_hi:[1,0,1] neg_lo:[0,1,0]
    v_cvt_pk_bf16_f32 v45, v24, -v25
    ds_write_addtid_b32 v45 offset:2304
    v_pk_mul_f32 v[38:39], v[36:37], v[30:31] op_sel:[0,0] op_sel_hi:[0,1]
    v_pk_fma_f32 v[38:39], v[36:37], v[30:31], v[38:39] op_sel:[1,1,0] op_sel_hi:[1,0,1] neg_lo:[0,1,0]
    v_cvt_pk_bf16_f32 v46, v38, -v39
    ds_write_addtid_b32 v46 offset:288
    v_pk_mul_f32 v[36:37], v[38:39], v[30:31] op_sel:[0,0] op_sel_hi:[0,1]
    v_pk_fma_f32 v[36:37], v[38:39], v[30:31], v[36:37] op_sel:[1,1,0] op_sel_hi:[1,0,1] neg_lo:[0,1,0]
    v_cvt_pk_bf16_f32 v47, v36, -v37
    ds_write_addtid_b32 v47 offset:576
    v_pk_mul_f32 v[40:41], v[36:37], v[34:35] op_sel:[0,0] op_sel_hi:[0,1]
    v_pk_fma_f32 v[40:41], v[36:37], v[34:35], v[40:41] op_sel:[1,1,0] op_sel_hi:[1,0,1] neg_lo:[0,1,0]
    v_cvt_pk_bf16_f32 v44, v40, -v41
    ds_write_addtid_b32 v44 offset:2592
    v_pk_mul_f32 v[38:39], v[36:37], v[30:31] op_sel:[0,0] op_sel_hi:[0,1]
    v_pk_fma_f32 v[38:39], v[36:37], v[30:31], v[38:39] op_sel:[1,1,0] op_sel_hi:[1,0,1] neg_lo:[0,1,0]
    v_cvt_pk_bf16_f32 v45, v38, -v39
    ds_write_addtid_b32 v45 offset:864
    v_pk_mul_f32 v[36:37], v[38:39], v[30:31] op_sel:[0,0] op_sel_hi:[0,1]
    v_pk_fma_f32 v[36:37], v[38:39], v[30:31], v[36:37] op_sel:[1,1,0] op_sel_hi:[1,0,1] neg_lo:[0,1,0]
    v_cvt_pk_bf16_f32 v46, v36, -v37
    ds_write_addtid_b32 v46 offset:1152
    v_pk_mul_f32 v[26:27], v[36:37], v[34:35] op_sel:[0,0] op_sel_hi:[0,1]
    v_pk_fma_f32 v[26:27], v[36:37], v[34:35], v[26:27] op_sel:[1,1,0] op_sel_hi:[1,0,1] neg_lo:[0,1,0]
    v_cvt_pk_bf16_f32 v47, v26, -v27
    ds_write_addtid_b32 v47 offset:2880
    v_pk_mul_f32 v[38:39], v[36:37], v[30:31] op_sel:[0,0] op_sel_hi:[0,1]
    v_pk_fma_f32 v[38:39], v[36:37], v[30:31], v[38:39] op_sel:[1,1,0] op_sel_hi:[1,0,1] neg_lo:[0,1,0]
    v_cvt_pk_bf16_f32 v44, v38, -v39
    ds_write_addtid_b32 v44 offset:1440
    v_pk_mul_f32 v[36:37], v[38:39], v[30:31] op_sel:[0,0] op_sel_hi:[0,1]
    v_pk_fma_f32 v[36:37], v[38:39], v[30:31], v[36:37] op_sel:[1,1,0] op_sel_hi:[1,0,1] neg_lo:[0,1,0]
    v_cvt_pk_bf16_f32 v45, v36, -v37
    ds_write_addtid_b32 v45 offset:1728
    v_pk_mul_f32 v[40:41], v[36:37], v[34:35] op_sel:[0,0] op_sel_hi:[0,1]
    v_pk_fma_f32 v[40:41], v[36:37], v[34:35], v[40:41] op_sel:[1,1,0] op_sel_hi:[1,0,1] neg_lo:[0,1,0]
    v_cvt_pk_bf16_f32 v46, v40, -v41
    ds_write_addtid_b32 v46 offset:3168
    v_pk_mul_f32 v[38:39], v[36:37], v[30:31] op_sel:[0,0] op_sel_hi:[0,1]
    v_pk_fma_f32 v[38:39], v[36:37], v[30:31], v[38:39] op_sel:[1,1,0] op_sel_hi:[1,0,1] neg_lo:[0,1,0]
    v_cvt_pk_bf16_f32 v47, v38, -v39
    ds_write_addtid_b32 v47 offset:2016
    v_pk_mul_f32 v[28:29], v[24:25], v[32:33] op_sel:[0,0] op_sel_hi:[0,1]
    v_pk_fma_f32 v[28:29], v[24:25], v[32:33], v[28:29] op_sel:[1,1,0] op_sel_hi:[1,0,1] neg_lo:[0,1,0]
    v_cvt_pk_bf16_f32 v44, v28, -v29
    ds_write_addtid_b32 v44 offset:3456
    s_waitcnt vmcnt(0)
    v_add_u32 v23, s39, v8
    v_add_u32 v6, s39, v9
    v_add_u32 v7, s39, v10
    v_pk_mul_f32 v[36:37], v[26:27], v[34:35] op_sel:[0,0] op_sel_hi:[0,1]
    v_pk_fma_f32 v[36:37], v[26:27], v[34:35], v[36:37] op_sel:[1,1,0] op_sel_hi:[1,0,1] neg_lo:[0,1,0]
    v_cvt_pk_bf16_f32 v45, v36, -v37
    ds_write_addtid_b32 v45 offset:4608
    ds_read_b128 v[64:67], v23 offset:0
    v_pk_mul_f32 v[38:39], v[28:29], v[34:35] op_sel:[0,0] op_sel_hi:[0,1]
    v_pk_fma_f32 v[38:39], v[28:29], v[34:35], v[38:39] op_sel:[1,1,0] op_sel_hi:[1,0,1] neg_lo:[0,1,0]
    v_cvt_pk_bf16_f32 v46, v38, -v39
    ds_write_addtid_b32 v46 offset:4896
    ds_read_b128 v[68:71], v23 offset:64
    v_pk_mul_f32 v[40:41], v[36:37], v[34:35] op_sel:[0,0] op_sel_hi:[0,1]
    v_pk_fma_f32 v[40:41], v[36:37], v[34:35], v[40:41] op_sel:[1,1,0] op_sel_hi:[1,0,1] neg_lo:[0,1,0]
    v_cvt_pk_bf16_f32 v47, v40, -v41
    ds_write_addtid_b32 v47 offset:5184
    ds_read_b128 v[72:75], v23 offset:128
    v_pk_mul_f32 v[42:43], v[38:39], v[34:35] op_sel:[0,0] op_sel_hi:[0,1]
    v_pk_fma_f32 v[42:43], v[38:39], v[34:35], v[42:43] op_sel:[1,1,0] op_sel_hi:[1,0,1] neg_lo:[0,1,0]
    v_cvt_pk_bf16_f32 v44, v42, -v43
    ds_write_addtid_b32 v44 offset:5472
    ds_read_b128 v[76:79], v23 offset:192
    v_pk_mul_f32 v[36:37], v[24:25], v[34:35] op_sel:[0,0] op_sel_hi:[0,1]
    v_pk_fma_f32 v[36:37], v[24:25], v[34:35], v[36:37] op_sel:[1,1,0] op_sel_hi:[1,0,1] neg_lo:[0,1,0]
    v_cvt_pk_bf16_f32 v45, v36, -v37
    ds_write_addtid_b32 v45 offset:6912
    v_pk_mul_f32 v[38:39], v[42:43], v[34:35] op_sel:[0,0] op_sel_hi:[0,1]
    v_pk_fma_f32 v[38:39], v[42:43], v[34:35], v[38:39] op_sel:[1,1,0] op_sel_hi:[1,0,1] neg_lo:[0,1,0]
    v_cvt_pk_bf16_f32 v46, v38, -v39
    ds_write_addtid_b32 v46 offset:5760
    v_mov_b32 v31, 0x3f80
    v_pk_mul_f32 v[40:41], v[38:39], v[34:35] op_sel:[0,0] op_sel_hi:[0,1]
    v_pk_fma_f32 v[40:41], v[38:39], v[34:35], v[40:41] op_sel:[1,1,0] op_sel_hi:[1,0,1] neg_lo:[0,1,0]
    v_cvt_pk_bf16_f32 v47, v40, -v41
    ds_write_addtid_b32 v47 offset:6048
    ds_write_addtid_b32 v31 offset:0
    v_pk_mul_f32 v[38:39], v[40:41], v[34:35] op_sel:[0,0] op_sel_hi:[0,1]
    v_pk_fma_f32 v[38:39], v[40:41], v[34:35], v[38:39] op_sel:[1,1,0] op_sel_hi:[1,0,1] neg_lo:[0,1,0]
    v_cvt_pk_bf16_f32 v44, v38, -v39
    ds_write_addtid_b32 v44 offset:6336
    v_pk_mul_f32 v[40:41], v[38:39], v[34:35] op_sel:[0,0] op_sel_hi:[0,1]
    v_pk_fma_f32 v[40:41], v[38:39], v[34:35], v[40:41] op_sel:[1,1,0] op_sel_hi:[1,0,1] neg_lo:[0,1,0]
    v_cvt_pk_bf16_f32 v45, v40, -v41
    ds_write_addtid_b32 v45 offset:6624
    v_cvt_pk_bf16_f32 v46, v32, v33
    ds_write_addtid_b32 v46 offset:288
    v_pk_mul_f32 v[36:37], v[32:33], v[32:33] op_sel:[0,0] op_sel_hi:[0,1]
    v_pk_fma_f32 v[36:37], v[32:33], v[32:33], v[36:37] op_sel:[1,1,0] op_sel_hi:[1,0,1] neg_lo:[0,1,0]
    v_cvt_pk_bf16_f32 v47, v36, v37
    ds_write_addtid_b32 v47 offset:576
    ds_read_b128 v[80:83], v6 offset:0
    v_pk_mul_f32 v[38:39], v[36:37], v[32:33] op_sel:[0,0] op_sel_hi:[0,1]
    v_pk_fma_f32 v[38:39], v[36:37], v[32:33], v[38:39] op_sel:[1,1,0] op_sel_hi:[1,0,1] neg_lo:[0,1,0]
    v_cvt_pk_bf16_f32 v44, v38, v39
    ds_write_addtid_b32 v44 offset:864
    ds_read_b128 v[84:87], v6 offset:64
    v_pk_mul_f32 v[36:37], v[38:39], v[32:33] op_sel:[0,0] op_sel_hi:[0,1]
    v_pk_fma_f32 v[36:37], v[38:39], v[32:33], v[36:37] op_sel:[1,1,0] op_sel_hi:[1,0,1] neg_lo:[0,1,0]
    v_cvt_pk_bf16_f32 v45, v36, v37
    ds_write_addtid_b32 v45 offset:1152
    ds_read_b128 v[88:91], v6 offset:128
    v_pk_mul_f32 v[38:39], v[36:37], v[32:33] op_sel:[0,0] op_sel_hi:[0,1]
    v_pk_fma_f32 v[38:39], v[36:37], v[32:33], v[38:39] op_sel:[1,1,0] op_sel_hi:[1,0,1] neg_lo:[0,1,0]
    v_cvt_pk_bf16_f32 v46, v38, v39
    ds_write_addtid_b32 v46 offset:1440
    ds_read_b128 v[92:95], v6 offset:192
    v_pk_mul_f32 v[36:37], v[38:39], v[32:33] op_sel:[0,0] op_sel_hi:[0,1]
    v_pk_fma_f32 v[36:37], v[38:39], v[32:33], v[36:37] op_sel:[1,1,0] op_sel_hi:[1,0,1] neg_lo:[0,1,0]
    v_cvt_pk_bf16_f32 v47, v36, v37
    ds_write_addtid_b32 v47 offset:1728
    s_barrier
    ds_read_b128 v[8:11], v1 offset:0
    v_pk_mul_f32 v[38:39], v[36:37], v[32:33] op_sel:[0,0] op_sel_hi:[0,1]
    v_pk_fma_f32 v[38:39], v[36:37], v[32:33], v[38:39] op_sel:[1,1,0] op_sel_hi:[1,0,1] neg_lo:[0,1,0]
    v_cvt_pk_bf16_f32 v44, v38, v39
    ds_write_addtid_b32 v44 offset:2016
    ds_read_b128 v[12:15], v1 offset:1024
    v_pk_mul_f32 v[36:37], v[38:39], v[32:33] op_sel:[0,0] op_sel_hi:[0,1]
    v_pk_fma_f32 v[36:37], v[38:39], v[32:33], v[36:37] op_sel:[1,1,0] op_sel_hi:[1,0,1] neg_lo:[0,1,0]
    v_cvt_pk_bf16_f32 v45, v36, v37
    ds_write_addtid_b32 v45 offset:2304
    ds_read_b128 v[16:19], v1 offset:2048
    v_pk_mul_f32 v[38:39], v[36:37], v[32:33] op_sel:[0,0] op_sel_hi:[0,1]
    v_pk_fma_f32 v[38:39], v[36:37], v[32:33], v[38:39] op_sel:[1,1,0] op_sel_hi:[1,0,1] neg_lo:[0,1,0]
    v_cvt_pk_bf16_f32 v46, v38, v39
    ds_write_addtid_b32 v46 offset:2592
    ds_read_b128 v[20:23], v1 offset:3072
    v_pk_mul_f32 v[36:37], v[38:39], v[32:33] op_sel:[0,0] op_sel_hi:[0,1]
    v_pk_fma_f32 v[36:37], v[38:39], v[32:33], v[36:37] op_sel:[1,1,0] op_sel_hi:[1,0,1] neg_lo:[0,1,0]
    v_cvt_pk_bf16_f32 v47, v36, v37
    ds_write_addtid_b32 v47 offset:2880
    v_pk_mul_f32 v[38:39], v[36:37], v[32:33] op_sel:[0,0] op_sel_hi:[0,1]
    v_pk_fma_f32 v[38:39], v[36:37], v[32:33], v[38:39] op_sel:[1,1,0] op_sel_hi:[1,0,1] neg_lo:[0,1,0]
    v_cvt_pk_bf16_f32 v44, v38, v39
    ds_write_addtid_b32 v44 offset:3168
    v_pk_mul_f32 v[36:37], v[38:39], v[32:33] op_sel:[0,0] op_sel_hi:[0,1]
    v_pk_fma_f32 v[36:37], v[38:39], v[32:33], v[36:37] op_sel:[1,1,0] op_sel_hi:[1,0,1] neg_lo:[0,1,0]
    v_cvt_pk_bf16_f32 v45, v36, v37
    ds_write_addtid_b32 v45 offset:3456
    s_waitcnt lgkmcnt(3)
    v_mov_b32 v1, v20
    v_add_u32 v20, s43, v22
    v_pk_mul_f32 v[38:39], v[36:37], v[32:33] op_sel:[0,0] op_sel_hi:[0,1]
    v_pk_fma_f32 v[38:39], v[36:37], v[32:33], v[38:39] op_sel:[1,1,0] op_sel_hi:[1,0,1] neg_lo:[0,1,0]
    v_cvt_pk_bf16_f32 v46, v38, v39
    ds_write_addtid_b32 v46 offset:3744
    v_add_u32 v6, s39, v22
    v_add_u32 v22, s44, v22
    v_add_u32 v21, s42, v21
    v_pk_mul_f32 v[36:37], v[38:39], v[32:33] op_sel:[0,0] op_sel_hi:[0,1]
    v_pk_fma_f32 v[36:37], v[38:39], v[32:33], v[36:37] op_sel:[1,1,0] op_sel_hi:[1,0,1] neg_lo:[0,1,0]
    v_cvt_pk_bf16_f32 v47, v36, v37
    ds_write_addtid_b32 v47 offset:4032
    v_add_u32 v10, s41, v10
    v_add_u32 v11, s41, v11
    v_pk_mul_f32 v[38:39], v[36:37], v[32:33] op_sel:[0,0] op_sel_hi:[0,1]
    v_pk_fma_f32 v[38:39], v[36:37], v[32:33], v[38:39] op_sel:[1,1,0] op_sel_hi:[1,0,1] neg_lo:[0,1,0]
    v_cvt_pk_bf16_f32 v44, v38, v39
    ds_write_addtid_b32 v44 offset:4320
    v_add_u32 v13, s50, v13
    v_add_u32 v18, s52, v18
    ds_read_b128 v[96:99], v7 offset:0
    ds_read_b128 v[100:103], v7 offset:64
    ds_read_b128 v[104:107], v7 offset:128
    ds_read_b128 v[108:111], v7 offset:192
    v_pk_mul_f32 v[36:37], v[38:39], v[32:33] op_sel:[0,0] op_sel_hi:[0,1]
    v_pk_fma_f32 v[36:37], v[38:39], v[32:33], v[36:37] op_sel:[1,1,0] op_sel_hi:[1,0,1] neg_lo:[0,1,0]
    v_cvt_pk_bf16_f32 v45, v36, v37
    ds_write_addtid_b32 v45 offset:0
    v_add_u32 v19, s53, v19
    v_add_u32 v3, s46, v3
    v_pk_mul_f32 v[38:39], v[36:37], v[32:33] op_sel:[0,0] op_sel_hi:[0,1]
    v_pk_fma_f32 v[38:39], v[36:37], v[32:33], v[38:39] op_sel:[1,1,0] op_sel_hi:[1,0,1] neg_lo:[0,1,0]
    v_cvt_pk_bf16_f32 v46, v38, v39
    ds_write_addtid_b32 v46 offset:288
    v_add_u32 v4, s47, v4
    v_add_u32 v2, s49, v2
    v_pk_mul_f32 v[36:37], v[38:39], v[32:33] op_sel:[0,0] op_sel_hi:[0,1]
    v_pk_fma_f32 v[36:37], v[38:39], v[32:33], v[36:37] op_sel:[1,1,0] op_sel_hi:[1,0,1] neg_lo:[0,1,0]
    v_cvt_pk_bf16_f32 v47, v36, v37
    ds_write_addtid_b32 v47 offset:576
    v_add_u32 v5, s49, v5
    v_add_u32 v8, s49, v8
    v_pk_mul_f32 v[38:39], v[36:37], v[32:33] op_sel:[0,0] op_sel_hi:[0,1]
    v_pk_fma_f32 v[38:39], v[36:37], v[32:33], v[38:39] op_sel:[1,1,0] op_sel_hi:[1,0,1] neg_lo:[0,1,0]
    v_cvt_pk_bf16_f32 v44, v38, v39
    ds_write_addtid_b32 v44 offset:864
    v_add_u32 v9, s49, v9
    v_add_u32 v14, s49, v14
    s_waitcnt lgkmcnt(7)
    v_mfma_f32_16x16x32_bf16 v[48:51], v[64:67], v[96:99], 0
    v_pk_mul_f32 v[36:37], v[38:39], v[32:33] op_sel:[0,0] op_sel_hi:[0,1]
    v_pk_fma_f32 v[36:37], v[38:39], v[32:33], v[36:37] op_sel:[1,1,0] op_sel_hi:[1,0,1] neg_lo:[0,1,0]
    v_cvt_pk_bf16_f32 v45, v36, v37
    ds_write_addtid_b32 v45 offset:1152
    v_add_u32 v15, s49, v15
    v_add_u32 v16, s49, v16
    v_mfma_f32_16x16x32_bf16 v[56:59], v[80:83], v[96:99], 0
    v_pk_mul_f32 v[38:39], v[36:37], v[32:33] op_sel:[0,0] op_sel_hi:[0,1]
    v_pk_fma_f32 v[38:39], v[36:37], v[32:33], v[38:39] op_sel:[1,1,0] op_sel_hi:[1,0,1] neg_lo:[0,1,0]
    v_cvt_pk_bf16_f32 v46, v38, v39
    ds_write_addtid_b32 v46 offset:1440
    v_add_u32 v17, s49, v17
    v_mov_b32 v40, 0
    s_waitcnt lgkmcnt(8)
    v_mfma_f32_16x16x32_bf16 v[48:51], v[68:71], v[100:103], v[48:51]
    v_pk_mul_f32 v[36:37], v[38:39], v[32:33] op_sel:[0,0] op_sel_hi:[0,1]
    v_pk_fma_f32 v[36:37], v[38:39], v[32:33], v[36:37] op_sel:[1,1,0] op_sel_hi:[1,0,1] neg_lo:[0,1,0]
    v_cvt_pk_bf16_f32 v47, v36, v37
    ds_write_addtid_b32 v47 offset:1728
    v_mov_b32 v41, 0
    v_mov_b32 v42, 0
    v_mov_b32 v43, 0
    v_mfma_f32_16x16x32_bf16 v[56:59], v[84:87], v[100:103], v[56:59]
    v_pk_mul_f32 v[38:39], v[36:37], v[32:33] op_sel:[0,0] op_sel_hi:[0,1]
    v_pk_fma_f32 v[38:39], v[36:37], v[32:33], v[38:39] op_sel:[1,1,0] op_sel_hi:[1,0,1] neg_lo:[0,1,0]
    v_cvt_pk_bf16_f32 v44, v38, v39
    ds_write_addtid_b32 v44 offset:2016
    s_waitcnt lgkmcnt(9)
    v_mfma_f32_16x16x32_bf16 v[48:51], v[72:75], v[104:107], v[48:51]
    v_pk_mul_f32 v[36:37], v[38:39], v[32:33] op_sel:[0,0] op_sel_hi:[0,1]
    v_pk_fma_f32 v[36:37], v[38:39], v[32:33], v[36:37] op_sel:[1,1,0] op_sel_hi:[1,0,1] neg_lo:[0,1,0]
    v_cvt_pk_bf16_f32 v45, v36, v37
    ds_write_addtid_b32 v45 offset:2304
    v_mfma_f32_16x16x32_bf16 v[56:59], v[88:91], v[104:107], v[56:59]
    v_pk_mul_f32 v[38:39], v[36:37], v[32:33] op_sel:[0,0] op_sel_hi:[0,1]
    v_pk_fma_f32 v[38:39], v[36:37], v[32:33], v[38:39] op_sel:[1,1,0] op_sel_hi:[1,0,1] neg_lo:[0,1,0]
    v_cvt_pk_bf16_f32 v46, v38, v39
    ds_write_addtid_b32 v46 offset:2592
    s_waitcnt lgkmcnt(10)
    v_mfma_f32_16x16x32_bf16 v[48:51], v[76:79], v[108:111], v[48:51]
    v_pk_mul_f32 v[36:37], v[38:39], v[32:33] op_sel:[0,0] op_sel_hi:[0,1]
    v_pk_fma_f32 v[36:37], v[38:39], v[32:33], v[36:37] op_sel:[1,1,0] op_sel_hi:[1,0,1] neg_lo:[0,1,0]
    v_cvt_pk_bf16_f32 v47, v36, v37
    ds_write_addtid_b32 v47 offset:2880
    v_mfma_f32_16x16x32_bf16 v[56:59], v[92:95], v[108:111], v[56:59]
    v_pk_mul_f32 v[38:39], v[36:37], v[32:33] op_sel:[0,0] op_sel_hi:[0,1]
    v_pk_fma_f32 v[38:39], v[36:37], v[32:33], v[38:39] op_sel:[1,1,0] op_sel_hi:[1,0,1] neg_lo:[0,1,0]
    v_cvt_pk_bf16_f32 v44, v38, v39
    ds_write_addtid_b32 v44 offset:3168
    v_pk_mul_f32 v[36:37], v[38:39], v[32:33] op_sel:[0,0] op_sel_hi:[0,1]
    v_pk_fma_f32 v[36:37], v[38:39], v[32:33], v[36:37] op_sel:[1,1,0] op_sel_hi:[1,0,1] neg_lo:[0,1,0]
    v_cvt_pk_bf16_f32 v45, v36, v37
    ds_write_addtid_b32 v45 offset:3456
    v_pk_mul_f32 v[38:39], v[36:37], v[32:33] op_sel:[0,0] op_sel_hi:[0,1]
    v_pk_fma_f32 v[38:39], v[36:37], v[32:33], v[38:39] op_sel:[1,1,0] op_sel_hi:[1,0,1] neg_lo:[0,1,0]
    v_cvt_pk_bf16_f32 v46, v38, v39
    ds_write_addtid_b32 v46 offset:3744
    v_pk_mul_f32 v[36:37], v[38:39], v[32:33] op_sel:[0,0] op_sel_hi:[0,1]
    v_pk_fma_f32 v[36:37], v[38:39], v[32:33], v[36:37] op_sel:[1,1,0] op_sel_hi:[1,0,1] neg_lo:[0,1,0]
    v_cvt_pk_bf16_f32 v47, v36, v37
    ds_write_addtid_b32 v47 offset:4032
    v_pk_mul_f32 v[38:39], v[36:37], v[32:33] op_sel:[0,0] op_sel_hi:[0,1]
    v_pk_fma_f32 v[38:39], v[36:37], v[32:33], v[38:39] op_sel:[1,1,0] op_sel_hi:[1,0,1] neg_lo:[0,1,0]
    v_cvt_pk_bf16_f32 v44, v38, v39
    ds_write_addtid_b32 v44 offset:4320
    ds_read_b128 v[96:99], v7 offset:0
    ds_read_b128 v[100:103], v7 offset:64
    ds_read_b128 v[104:107], v7 offset:128
    ds_read_b128 v[108:111], v7 offset:192
    ds_write_b128 v6, v[48:51] offset:4608
    ds_write_b128 v6, v[56:59] offset:6656
    s_waitcnt lgkmcnt(5)
    v_mfma_f32_16x16x32_bf16 v[52:55], v[64:67], v[96:99], 0
    v_mfma_f32_16x16x32_bf16 v[60:63], v[80:83], v[96:99], 0
    s_waitcnt lgkmcnt(4)
    v_mfma_f32_16x16x32_bf16 v[52:55], v[68:71], v[100:103], v[52:55]
    v_mfma_f32_16x16x32_bf16 v[60:63], v[84:87], v[100:103], v[60:63]
    s_waitcnt lgkmcnt(3)
    v_mfma_f32_16x16x32_bf16 v[52:55], v[72:75], v[104:107], v[52:55]
    v_mfma_f32_16x16x32_bf16 v[60:63], v[88:91], v[104:107], v[60:63]
    s_waitcnt lgkmcnt(2)
    v_mfma_f32_16x16x32_bf16 v[52:55], v[76:79], v[108:111], v[52:55]
    v_mfma_f32_16x16x32_bf16 v[60:63], v[92:95], v[108:111], v[60:63]
    s_nop 6
    ds_write_b128 v6, v[52:55] offset:5632
    ds_write_b128 v6, v[60:63] offset:7680
    s_waitcnt lgkmcnt(0)
    s_barrier
    ds_read_b128 v[64:67], v2 offset:0
    ds_read_b128 v[68:71], v2 offset:8704
    ds_read_b128 v[72:75], v2 offset:17408
    ds_read_b128 v[76:79], v2 offset:26112
    ds_write_b128 v1, v[40:43]
    buffer_load_dwordx4 v[24:27], v22, s[28:31], s54 offen sc1
    buffer_load_dwordx4 v[28:31], v22, s[28:31], s55 offen sc1
    s_waitcnt lgkmcnt(3)
    v_pk_add_f32 v[64:65], v[64:65], v[68:69]
    v_pk_add_f32 v[66:67], v[66:67], v[70:71]
    s_waitcnt lgkmcnt(1)
    v_pk_add_f32 v[72:73], v[72:73], v[76:77]
    v_pk_add_f32 v[74:75], v[74:75], v[78:79]
    v_pk_add_f32 v[64:65], v[64:65], v[72:73]
    v_pk_add_f32 v[66:67], v[66:67], v[74:75]
    v_cvt_pk_bf16_f32 v70, v67, v66
    v_cvt_pk_bf16_f32 v71, v65, v64
    s_cmp_eq_u32 s37, 3
    s_cbranch_scc1 L_Bb3
    v_and_b32 v72, v3, v70
    v_and_b32 v73, v4, v71
    v_and_b32 v74, v4, v71
    v_mov_b32_dpp v75, v72 row_shr:1 row_mask:0xf bank_mask:0xf
    v_mov_b32_dpp v80, v73 row_shr:1 row_mask:0xf bank_mask:0xf
    v_alignbit_b32 v76, v73, v72, 16
    v_alignbit_b32 v77, v75, v73, 16
    v_alignbit_b32 v78, v75, v73, 16
    v_alignbit_b32 v79, v80, v75, 16
    ds_write_b64 v5, v[72:73]
    ds_write_b64 v5, v[76:77] offset:8768
    ds_write_b64 v5, v[74:75] offset:17536
    ds_write_b64 v5, v[78:79] offset:26304
    ds_write_b64 v5, v[72:73] offset:1528
    ds_write_b64 v5, v[76:77] offset:10296
    ds_write_b64 v5, v[74:75] offset:19064
    ds_write_b64 v5, v[78:79] offset:27832
    s_branch L_Bb4
L_Bb3:
    s_mov_b64 exec, 0xffffffff
    ds_write_b32 v3, v71 offset:128
    ds_write_b32 v3, v70
    s_not_b64 exec, exec
    ds_write_b16_d16_hi v4, v71 offset:192
    ds_write_b16 v4, v71 offset:128
    ds_write_b16_d16_hi v4, v70 offset:64
    ds_write_b16 v4, v70
    s_mov_b64 exec, -1
L_Bb4:
    v_mov_b32 v44, s56
    s_waitcnt lgkmcnt(0)
    s_barrier
    ds_read_b128 v[56:59], v8 offset:1024
    ds_read_b128 v[60:63], v8 offset:512
    ds_read_b128 v[64:67], v8 offset:960
    ds_read_b128 v[68:71], v8 offset:448
    ds_read_b128 v[72:75], v8 offset:896
    ds_read_b128 v[76:79], v8 offset:384
    ds_read_b128 v[80:83], v8 offset:832
    ds_read_b128 v[84:87], v8 offset:320
    ds_read_b128 v[88:91], v8 offset:768
    ds_read_b128 v[92:95], v8 offset:256
    ds_read_b128 v[96:99], v8 offset:704
    ds_read_b128 v[100:103], v8 offset:192
    ds_read_b128 v[104:107], v8 offset:640
    ds_read_b128 v[108:111], v8 offset:128
    s_cmp_eq_u32 s38, 0
    s_cbranch_scc1 L_noa16
    ds_read_b128 v[112:115], v8 offset:576
    ds_read_b128 v[116:119], v8 offset:64
    s_cmp_eq_u32 s38, 1
    s_cbranch_scc1 L_noa16
    ds_read_b128 v[120:123], v8 offset:0
    ds_read_b128 v[124:127], v8 offset:1152
L_noa16:
    s_mov_b64 exec, 1
    ds_write_b128 v44, v[40:43]
    ds_write_b64 v44, v[40:41] offset:16
    s_mov_b64 exec, -1
Lxg:
    s_waitcnt vmcnt(0)
    v_xor_b32 v45, s32, v25
    v_bitop3_b32 v45, v27, s33, v45 bitop3:0xbe
    v_bitop3_b32 v45, v29, s32, v45 bitop3:0xbe
    v_bitop3_b32 v45, v31, s33, v45 bitop3:0xbe
    v_cmp_ne_u32 vcc, 0, v45
    s_cmp_lg_u64 vcc, 0
    s_cbranch_scc0 Lxg_ok
    s_mov_b64 exec, vcc
    s_sleep 1
    s_add_u32 s62, s62, 1
    s_cmp_gt_u32 s62, 400000
    s_cbranch_scc1 Lxg_ok
    buffer_load_dwordx4 v[24:27], v22, s[28:31], s54 offen sc1
    buffer_load_dwordx4 v[28:31], v22, s[28:31], s55 offen sc1
    s_branch Lxg
Lxg_ok:
    s_mov_b64 exec, -1
    v_perm_b32 v25, v28, v24, v12
    v_perm_b32 v29, v28, v24, v23
    ds_write_b32 v10, v25 offset:0
    ds_write_b32 v11, v29 offset:0
    v_perm_b32 v27, v30, v26, v12
    v_perm_b32 v31, v30, v26, v23
    ds_write_b32 v10, v27 offset:512
    ds_write_b32 v11, v31 offset:512
    s_waitcnt lgkmcnt(0)
    s_barrier
    s_setprio 3
    s_cmp_eq_u32 s38, 1
    s_cbranch_scc1 L_conv1
    s_cmp_eq_u32 s38, 2
    s_cbranch_scc1 L_conv2
    s_cmp_eq_u32 s38, 3
    s_cbranch_scc1 L_conv3
L_conv0:
    ds_read_b128 v[32:35], v13 offset:496
    ds_read_b128 v[36:39], v13 offset:1008
    ds_read_b128 v[40:43], v13 offset:1520
    ds_read_b128 v[44:47], v13 offset:2032
    s_waitcnt lgkmcnt(3)
    v_mfma_f32_16x16x32_bf16 v[2:5], v[120:123], v[32:35], 0
    v_mfma_f32_16x16x32_bf16 v[52:55], v[124:127], v[32:35], 0
    v_mfma_f32_16x16x32_bf16 v[48:51], v[112:115], v[32:35], 0
    s_nop 5
    v_cvt_pk_bf16_f32 v2, v2, v3
    v_cvt_pk_bf16_f32 v3, v4, v5
    ds_write_b64 v15, v[2:3] offset:128
    v_mfma_f32_16x16x32_bf16 v[2:5], v[116:119], v[32:35], 0
    v_cvt_pk_bf16_f32 v52, v52, v53
    v_cvt_pk_bf16_f32 v53, v54, v55
    ds_write_b64 v15, v[52:53] offset:8704
    ds_read_b128 v[32:35], v13 offset:992
    s_waitcnt lgkmcnt(5)
    v_mfma_f32_16x16x32_bf16 v[52:55], v[120:123], v[36:39], 0
    v_cvt_pk_bf16_f32 v48, v48, v49
    v_cvt_pk_bf16_f32 v49, v50, v51
    ds_write_b64 v15, v[48:49] offset:17456
    v_mfma_f32_16x16x32_bf16 v[48:51], v[124:127], v[36:39], 0
    v_cvt_pk_bf16_f32 v2, v2, v3
    v_cvt_pk_bf16_f32 v3, v4, v5
    ds_write_b64 v15, v[2:3] offset:26112
    v_mfma_f32_16x16x32_bf16 v[2:5], v[112:115], v[36:39], 0
    v_cvt_pk_bf16_f32 v52, v52, v53
    v_cvt_pk_bf16_f32 v53, v54, v55
    ds_write_b64 v15, v[52:53] offset:672
    v_mfma_f32_16x16x32_bf16 v[52:55], v[116:119], v[36:39], 0
    v_cvt_pk_bf16_f32 v48, v48, v49
    v_cvt_pk_bf16_f32 v49, v50, v51
    ds_write_b64 v15, v[48:49] offset:9248
    ds_read_b128 v[36:39], v13 offset:480
    s_waitcnt lgkmcnt(9)
    v_mfma_f32_16x16x32_bf16 v[48:51], v[120:123], v[40:43], 0
    v_cvt_pk_bf16_f32 v2, v2, v3
    v_cvt_pk_bf16_f32 v3, v4, v5
    ds_write_b64 v15, v[2:3] offset:18000
    v_mfma_f32_16x16x32_bf16 v[2:5], v[124:127], v[40:43], 0
    v_cvt_pk_bf16_f32 v52, v52, v53
    v_cvt_pk_bf16_f32 v53, v54, v55
    ds_write_b64 v15, v[52:53] offset:26656
    v_mfma_f32_16x16x32_bf16 v[52:55], v[112:115], v[40:43], 0
    v_cvt_pk_bf16_f32 v48, v48, v49
    v_cvt_pk_bf16_f32 v49, v50, v51
    ds_write_b64 v15, v[48:49] offset:1216
    v_mfma_f32_16x16x32_bf16 v[48:51], v[116:119], v[40:43], 0
    v_cvt_pk_bf16_f32 v2, v2, v3
    v_cvt_pk_bf16_f32 v3, v4, v5
    ds_write_b64 v15, v[2:3] offset:9792
    s_waitcnt lgkmcnt(12)
    v_mfma_f32_16x16x32_bf16 v[2:5], v[120:123], v[44:47], 0
    v_cvt_pk_bf16_f32 v52, v52, v53
    v_cvt_pk_bf16_f32 v53, v54, v55
    ds_write_b64 v15, v[52:53] offset:18544
    v_mfma_f32_16x16x32_bf16 v[52:55], v[124:127], v[44:47], 0
    v_cvt_pk_bf16_f32 v48, v48, v49
    v_cvt_pk_bf16_f32 v49, v50, v51
    ds_write_b64 v15, v[48:49] offset:27200
    v_mfma_f32_16x16x32_bf16 v[48:51], v[112:115], v[44:47], 0
    v_cvt_pk_bf16_f32 v2, v2, v3
    v_cvt_pk_bf16_f32 v3, v4, v5
    ds_write_b64 v15, v[2:3] offset:1760
    v_mfma_f32_16x16x32_bf16 v[2:5], v[116:119], v[44:47], 0
    v_cvt_pk_bf16_f32 v52, v52, v53
    v_cvt_pk_bf16_f32 v53, v54, v55
    ds_write_b64 v15, v[52:53] offset:10336
    s_nop 0
    v_cvt_pk_bf16_f32 v48, v48, v49
    v_cvt_pk_bf16_f32 v49, v50, v51
    ds_write_b64 v15, v[48:49] offset:19088
    s_nop 0
    v_cvt_pk_bf16_f32 v2, v2, v3
    v_cvt_pk_bf16_f32 v3, v4, v5
    ds_write_b64 v15, v[2:3] offset:27744
    s_waitcnt lgkmcnt(0)
    s_barrier
    ds_read_b128 v[40:43], v13 offset:928
    ds_read_b128 v[44:47], v13 offset:416
    ds_read_b128 v[2:5], v13 offset:864
    v_mfma_f32_16x16x32_bf16 v[28:31], v[56:59], v[32:35], 0
    ds_read_b128 v[52:55], v13 offset:352
    ds_read_b128 v[48:51], v13 offset:800
    v_mfma_f32_16x16x32_bf16 v[24:27], v[56:59], v[36:39], 0
    ds_read_b128 v[120:123], v13 offset:288
    ds_read_b128 v[124:127], v13 offset:736
    v_mfma_f32_16x16x32_bf16 v[28:31], v[60:63], v[36:39], v[28:31]
    ds_read_b128 v[112:115], v13 offset:224
    ds_read_b128 v[116:119], v13 offset:672
    s_waitcnt lgkmcnt(8)
    v_mfma_f32_16x16x32_bf16 v[28:31], v[64:67], v[40:43], v[28:31]
    ds_read_b128 v[32:35], v13 offset:160
    ds_read_b128 v[56:59], v13 offset:608
    s_waitcnt lgkmcnt(9)
    v_mfma_f32_16x16x32_bf16 v[24:27], v[64:67], v[44:47], v[24:27]
    ds_read_b128 v[60:63], v13 offset:96
    ds_read_b128 v[36:39], v8 offset:576
    v_mfma_f32_16x16x32_bf16 v[28:31], v[68:71], v[44:47], v[28:31]
    ds_read_b128 v[40:43], v13 offset:544
    ds_read_b128 v[64:67], v13 offset:32
    s_waitcnt lgkmcnt(12)
    v_mfma_f32_16x16x32_bf16 v[28:31], v[72:75], v[2:5], v[28:31]
    ds_read_b128 v[68:71], v8 offset:64
    s_waitcnt lgkmcnt(12)
    v_mfma_f32_16x16x32_bf16 v[24:27], v[72:75], v[52:55], v[24:27]
    v_mfma_f32_16x16x32_bf16 v[28:31], v[76:79], v[52:55], v[28:31]
    s_waitcnt lgkmcnt(11)
    v_mfma_f32_16x16x32_bf16 v[28:31], v[80:83], v[48:51], v[28:31]
    s_waitcnt lgkmcnt(10)
    v_mfma_f32_16x16x32_bf16 v[24:27], v[80:83], v[120:123], v[24:27]
    v_mfma_f32_16x16x32_bf16 v[28:31], v[84:87], v[120:123], v[28:31]
    s_waitcnt lgkmcnt(9)
    v_mfma_f32_16x16x32_bf16 v[28:31], v[88:91], v[124:127], v[28:31]
    s_waitcnt lgkmcnt(8)
    v_mfma_f32_16x16x32_bf16 v[24:27], v[88:91], v[112:115], v[24:27]
    v_mfma_f32_16x16x32_bf16 v[28:31], v[92:95], v[112:115], v[28:31]
    s_waitcnt lgkmcnt(7)
    v_mfma_f32_16x16x32_bf16 v[28:31], v[96:99], v[116:119], v[28:31]
    s_waitcnt lgkmcnt(6)
    v_mfma_f32_16x16x32_bf16 v[24:27], v[96:99], v[32:35], v[24:27]
    v_mfma_f32_16x16x32_bf16 v[28:31], v[100:103], v[32:35], v[28:31]
    s_waitcnt lgkmcnt(5)
    v_mfma_f32_16x16x32_bf16 v[28:31], v[104:107], v[56:59], v[28:31]
    s_waitcnt lgkmcnt(4)
    v_mfma_f32_16x16x32_bf16 v[24:27], v[104:107], v[60:63], v[24:27]
    v_mfma_f32_16x16x32_bf16 v[28:31], v[108:111], v[60:63], v[28:31]
    s_waitcnt lgkmcnt(2)
    v_mfma_f32_16x16x32_bf16 v[28:31], v[36:39], v[40:43], v[28:31]
    s_waitcnt lgkmcnt(1)
    v_mfma_f32_16x16x32_bf16 v[24:27], v[36:39], v[64:67], v[24:27]
    s_waitcnt lgkmcnt(0)
    v_mfma_f32_16x16x32_bf16 v[28:31], v[68:71], v[64:67], v[28:31]
    s_nop 7
    v_cvt_pk_bf16_f32 v40, v24, v28
    v_cvt_pk_bf16_f32 v41, v25, v29
    v_cvt_pk_bf16_f32 v42, v26, v30
    v_cvt_pk_bf16_f32 v43, v27, v31
    ds_write_b128 v20, v[40:43]
    s_branch L_Bout
L_conv1:
    ds_read_b128 v[32:35], v13 offset:2544
    ds_read_b128 v[36:39], v13 offset:3056
    ds_read_b128 v[40:43], v13 offset:2016
    ds_read_b128 v[44:47], v13 offset:1504
    s_waitcnt lgkmcnt(3)
    v_mfma_f32_16x16x32_bf16 v[2:5], v[120:123], v[32:35], 0
    v_mfma_f32_16x16x32_bf16 v[52:55], v[124:127], v[32:35], 0
    ds_read_b128 v[32:35], v13 offset:992
    s_waitcnt lgkmcnt(3)
    v_mfma_f32_16x16x32_bf16 v[48:51], v[120:123], v[36:39], 0
    s_nop 3
    v_cvt_pk_bf16_f32 v2, v2, v3
    v_cvt_pk_bf16_f32 v3, v4, v5
    ds_write_b64 v15, v[2:3] offset:2304
    v_mfma_f32_16x16x32_bf16 v[2:5], v[124:127], v[36:39], 0
    v_cvt_pk_bf16_f32 v52, v52, v53
    v_cvt_pk_bf16_f32 v53, v54, v55
    ds_write_b64 v15, v[52:53] offset:10880
    ds_read_b128 v[36:39], v8 offset:0
    s_waitcnt lgkmcnt(5)
    v_mfma_f32_16x16x32_bf16 v[28:31], v[56:59], v[40:43], 0
    ds_read_b128 v[40:43], v13 offset:480
    s_waitcnt lgkmcnt(5)
    v_mfma_f32_16x16x32_bf16 v[24:27], v[56:59], v[44:47], 0
    ds_read_b128 v[56:59], v13 offset:1952
    v_mfma_f32_16x16x32_bf16 v[28:31], v[60:63], v[44:47], v[28:31]
    ds_read_b128 v[44:47], v13 offset:1440
    s_waitcnt lgkmcnt(6)
    v_mfma_f32_16x16x32_bf16 v[24:27], v[60:63], v[32:35], v[24:27]
    ds_read_b128 v[60:63], v13 offset:928
    s_waitcnt lgkmcnt(4)
    v_mfma_f32_16x16x32_bf16 v[28:31], v[36:39], v[32:35], v[28:31]
    ds_read_b128 v[32:35], v13 offset:1888
    s_waitcnt lgkmcnt(4)
    v_mfma_f32_16x16x32_bf16 v[24:27], v[36:39], v[40:43], v[24:27]
    ds_read_b128 v[36:39], v13 offset:1376
    ds_read_b128 v[40:43], v13 offset:864
    s_waitcnt lgkmcnt(5)
    v_mfma_f32_16x16x32_bf16 v[28:31], v[64:67], v[56:59], v[28:31]
    ds_read_b128 v[56:59], v13 offset:1824
    s_waitcnt lgkmcnt(5)
    v_mfma_f32_16x16x32_bf16 v[24:27], v[64:67], v[44:47], v[24:27]
    ds_read_b128 v[64:67], v13 offset:1312
    v_mfma_f32_16x16x32_bf16 v[28:31], v[68:71], v[44:47], v[28:31]
    ds_read_b128 v[44:47], v13 offset:800
    s_waitcnt lgkmcnt(6)
    v_mfma_f32_16x16x32_bf16 v[24:27], v[68:71], v[60:63], v[24:27]
    ds_read_b128 v[68:71], v13 offset:1760
    ds_read_b128 v[60:63], v13 offset:1248
    s_waitcnt lgkmcnt(7)
    v_mfma_f32_16x16x32_bf16 v[28:31], v[72:75], v[32:35], v[28:31]
    ds_read_b128 v[32:35], v13 offset:736
    s_waitcnt lgkmcnt(7)
    v_mfma_f32_16x16x32_bf16 v[24:27], v[72:75], v[36:39], v[24:27]
    ds_read_b128 v[72:75], v13 offset:1696
    v_mfma_f32_16x16x32_bf16 v[28:31], v[76:79], v[36:39], v[28:31]
    ds_read_b128 v[36:39], v13 offset:1184
    s_waitcnt lgkmcnt(8)
    v_mfma_f32_16x16x32_bf16 v[24:27], v[76:79], v[40:43], v[24:27]
    ds_read_b128 v[76:79], v13 offset:672
    ds_read_b128 v[40:43], v13 offset:1632
    s_waitcnt lgkmcnt(9)
    v_mfma_f32_16x16x32_bf16 v[28:31], v[80:83], v[56:59], v[28:31]
    ds_read_b128 v[56:59], v13 offset:1120
    s_waitcnt lgkmcnt(9)
    v_mfma_f32_16x16x32_bf16 v[24:27], v[80:83], v[64:67], v[24:27]
    ds_read_b128 v[80:83], v13 offset:608
    v_mfma_f32_16x16x32_bf16 v[28:31], v[84:87], v[64:67], v[28:31]
    ds_read_b128 v[64:67], v13 offset:1568
    s_waitcnt lgkmcnt(10)
    v_mfma_f32_16x16x32_bf16 v[24:27], v[84:87], v[44:47], v[24:27]
    ds_read_b128 v[84:87], v13 offset:1056
    ds_read_b128 v[44:47], v13 offset:544
    s_waitcnt lgkmcnt(11)
    v_mfma_f32_16x16x32_bf16 v[28:31], v[88:91], v[68:71], v[28:31]
    s_waitcnt lgkmcnt(10)
    v_mfma_f32_16x16x32_bf16 v[24:27], v[88:91], v[60:63], v[24:27]
    v_mfma_f32_16x16x32_bf16 v[28:31], v[92:95], v[60:63], v[28:31]
    s_waitcnt lgkmcnt(9)
    v_mfma_f32_16x16x32_bf16 v[24:27], v[92:95], v[32:35], v[24:27]
    s_waitcnt lgkmcnt(8)
    v_mfma_f32_16x16x32_bf16 v[28:31], v[96:99], v[72:75], v[28:31]
    s_waitcnt lgkmcnt(7)
    v_mfma_f32_16x16x32_bf16 v[24:27], v[96:99], v[36:39], v[24:27]
    v_mfma_f32_16x16x32_bf16 v[28:31], v[100:103], v[36:39], v[28:31]
    s_waitcnt lgkmcnt(6)
    v_mfma_f32_16x16x32_bf16 v[24:27], v[100:103], v[76:79], v[24:27]
    v_cvt_pk_bf16_f32 v48, v48, v49
    v_cvt_pk_bf16_f32 v49, v50, v51
    ds_write_b64 v15, v[48:49] offset:2848
    v_cvt_pk_bf16_f32 v2, v2, v3
    v_cvt_pk_bf16_f32 v3, v4, v5
    ds_write_b64 v15, v[2:3] offset:11424
    s_waitcnt lgkmcnt(0)
    s_barrier
    ds_read_b64_tr_b16 v[68:69], v16 offset:0
    ds_read_b64_tr_b16 v[70:71], v14 offset:0
    ds_read_b64 v[88:89], v18 offset:256
    ds_read_b64 v[90:91], v18 offset:264
    ds_read_b64 v[60:61], v18 offset:128
    ds_read_b64 v[62:63], v18 offset:136
    v_mfma_f32_16x16x32_bf16 v[28:31], v[104:107], v[40:43], v[28:31]
    ds_read_b64_tr_b16 v[92:93], v16 offset:272
    ds_read_b64_tr_b16 v[94:95], v14 offset:272
    ds_read_b64 v[32:33], v18 offset:320
    ds_read_b64 v[34:35], v18 offset:328
    v_mfma_f32_16x16x32_bf16 v[24:27], v[104:107], v[56:59], v[24:27]
    ds_read_b64 v[72:73], v18 offset:192
    ds_read_b64 v[74:75], v18 offset:200
    ds_read_b64_tr_b16 v[96:97], v16 offset:544
    ds_read_b64_tr_b16 v[98:99], v14 offset:544
    v_mfma_f32_16x16x32_bf16 v[28:31], v[108:111], v[56:59], v[28:31]
    v_mfma_f32_16x16x32_bf16 v[24:27], v[108:111], v[80:83], v[24:27]
    v_mfma_f32_16x16x32_bf16 v[28:31], v[112:115], v[64:67], v[28:31]
    v_mfma_f32_16x16x32_bf16 v[24:27], v[112:115], v[84:87], v[24:27]
    v_mfma_f32_16x16x32_bf16 v[28:31], v[116:119], v[84:87], v[28:31]
    v_mfma_f32_16x16x32_bf16 v[24:27], v[116:119], v[44:47], v[24:27]
    s_waitcnt lgkmcnt(10)
    v_mfma_f32_16x16x32_bf16 v[24:27], v[68:71], v[88:91], v[24:27]
    ds_read_b64_tr_b16 v[36:37], v16 offset:816
    ds_read_b64_tr_b16 v[38:39], v14 offset:816
    s_waitcnt lgkmcnt(10)
    v_mfma_f32_16x16x32_bf16 v[28:31], v[68:71], v[60:63], v[28:31]
    s_waitcnt lgkmcnt(6)
    v_mfma_f32_16x16x32_bf16 v[24:27], v[92:95], v[32:35], v[24:27]
    s_waitcnt lgkmcnt(4)
    v_mfma_f32_16x16x32_bf16 v[28:31], v[92:95], v[72:75], v[28:31]
    s_waitcnt lgkmcnt(2)
    v_mfma_f32_16x16x32_bf16 v[28:31], v[96:99], v[88:91], v[28:31]
    s_waitcnt lgkmcnt(0)
    v_mfma_f32_16x16x32_bf16 v[28:31], v[36:39], v[32:35], v[28:31]
    s_nop 7
    v_cvt_pk_bf16_f32 v40, v24, v28
    v_cvt_pk_bf16_f32 v41, v25, v29
    v_cvt_pk_bf16_f32 v42, v26, v30
    v_cvt_pk_bf16_f32 v43, v27, v31
    ds_write_b128 v20, v[40:43]
    s_branch L_Bout
L_conv2:
    ds_read_b128 v[32:35], v13 offset:3040
    ds_read_b128 v[36:39], v13 offset:2528
    ds_read_b128 v[40:43], v13 offset:2016
    ds_read_b128 v[44:47], v13 offset:1504
    ds_read_b128 v[48:51], v13 offset:992
    ds_read_b128 v[52:55], v13 offset:480
    s_waitcnt lgkmcnt(5)
    v_mfma_f32_16x16x32_bf16 v[28:31], v[56:59], v[32:35], 0
    ds_read_b128 v[2:5], v13 offset:2976
    ds_read_b128 v[32:35], v13 offset:2464
    s_waitcnt lgkmcnt(6)
    v_mfma_f32_16x16x32_bf16 v[24:27], v[56:59], v[36:39], 0
    ds_read_b128 v[56:59], v13 offset:1952
    v_mfma_f32_16x16x32_bf16 v[28:31], v[60:63], v[36:39], v[28:31]
    ds_read_b128 v[36:39], v13 offset:2912
    s_waitcnt lgkmcnt(7)
    v_mfma_f32_16x16x32_bf16 v[24:27], v[60:63], v[40:43], v[24:27]
    ds_read_b128 v[60:63], v13 offset:2400
    v_mfma_f32_16x16x32_bf16 v[28:31], v[120:123], v[40:43], v[28:31]
    ds_read_b128 v[40:43], v13 offset:1888
    s_waitcnt lgkmcnt(8)
    v_mfma_f32_16x16x32_bf16 v[24:27], v[120:123], v[44:47], v[24:27]
    ds_read_b128 v[120:123], v13 offset:2848
    ds_read_b128 v[44:47], v13 offset:2336
    s_waitcnt lgkmcnt(9)
    v_mfma_f32_16x16x32_bf16 v[28:31], v[124:127], v[48:51], v[28:31]
    ds_read_b128 v[48:51], v13 offset:1824
    s_waitcnt lgkmcnt(9)
    v_mfma_f32_16x16x32_bf16 v[24:27], v[124:127], v[52:55], v[24:27]
    ds_read_b128 v[124:127], v13 offset:2784
    ds_read_b128 v[52:55], v13 offset:2272
    s_waitcnt lgkmcnt(10)
    v_mfma_f32_16x16x32_bf16 v[28:31], v[64:67], v[2:5], v[28:31]
    ds_read_b128 v[2:5], v13 offset:1760
    s_waitcnt lgkmcnt(10)
    v_mfma_f32_16x16x32_bf16 v[24:27], v[64:67], v[32:35], v[24:27]
    ds_read_b128 v[64:67], v13 offset:2720
    v_mfma_f32_16x16x32_bf16 v[28:31], v[68:71], v[32:35], v[28:31]
    ds_read_b128 v[32:35], v13 offset:2208
    s_waitcnt lgkmcnt(11)
    v_mfma_f32_16x16x32_bf16 v[24:27], v[68:71], v[56:59], v[24:27]
    ds_read_b128 v[68:71], v13 offset:1696
    ds_read_b128 v[56:59], v13 offset:2656
    s_waitcnt lgkmcnt(12)
    v_mfma_f32_16x16x32_bf16 v[28:31], v[72:75], v[36:39], v[28:31]
    ds_read_b128 v[36:39], v13 offset:2144
    s_waitcnt lgkmcnt(12)
    v_mfma_f32_16x16x32_bf16 v[24:27], v[72:75], v[60:63], v[24:27]
    ds_read_b128 v[72:75], v13 offset:1632
    v_mfma_f32_16x16x32_bf16 v[28:31], v[76:79], v[60:63], v[28:31]
    s_waitcnt lgkmcnt(12)
    v_mfma_f32_16x16x32_bf16 v[24:27], v[76:79], v[40:43], v[24:27]
    ds_read_b128 v[60:63], v13 offset:2592
    s_waitcnt lgkmcnt(12)
    v_mfma_f32_16x16x32_bf16 v[28:31], v[80:83], v[120:123], v[28:31]
    ds_read_b128 v[76:79], v13 offset:2080
    s_waitcnt lgkmcnt(12)
    v_mfma_f32_16x16x32_bf16 v[24:27], v[80:83], v[44:47], v[24:27]
    ds_read_b128 v[40:43], v13 offset:1568
    v_mfma_f32_16x16x32_bf16 v[28:31], v[84:87], v[44:47], v[28:31]
    s_waitcnt lgkmcnt(12)
    v_mfma_f32_16x16x32_bf16 v[24:27], v[84:87], v[48:51], v[24:27]
    s_waitcnt lgkmcnt(11)
    v_mfma_f32_16x16x32_bf16 v[28:31], v[88:91], v[124:127], v[28:31]
    s_waitcnt lgkmcnt(10)
    v_mfma_f32_16x16x32_bf16 v[24:27], v[88:91], v[52:55], v[24:27]
    v_mfma_f32_16x16x32_bf16 v[28:31], v[92:95], v[52:55], v[28:31]
    s_waitcnt lgkmcnt(9)
    v_mfma_f32_16x16x32_bf16 v[24:27], v[92:95], v[2:5], v[24:27]
    s_waitcnt lgkmcnt(8)
    v_mfma_f32_16x16x32_bf16 v[28:31], v[96:99], v[64:67], v[28:31]
    s_waitcnt lgkmcnt(7)
    v_mfma_f32_16x16x32_bf16 v[24:27], v[96:99], v[32:35], v[24:27]
    v_mfma_f32_16x16x32_bf16 v[28:31], v[100:103], v[32:35], v[28:31]
    s_waitcnt lgkmcnt(6)
    v_mfma_f32_16x16x32_bf16 v[24:27], v[100:103], v[68:71], v[24:27]
    s_waitcnt lgkmcnt(5)
    v_mfma_f32_16x16x32_bf16 v[28:31], v[104:107], v[56:59], v[28:31]
    s_waitcnt lgkmcnt(4)
    v_mfma_f32_16x16x32_bf16 v[24:27], v[104:107], v[36:39], v[24:27]
    v_mfma_f32_16x16x32_bf16 v[28:31], v[108:111], v[36:39], v[28:31]
    s_waitcnt lgkmcnt(3)
    v_mfma_f32_16x16x32_bf16 v[24:27], v[108:111], v[72:75], v[24:27]
    s_barrier
    ds_read_b64_tr_b16 v[120:121], v16 offset:0
    ds_read_b64_tr_b16 v[122:123], v14 offset:0
    ds_read_b64 v[80:81], v18 offset:0
    ds_read_b64 v[82:83], v18 offset:8
    ds_read_b64_tr_b16 v[44:45], v16 offset:272
    ds_read_b64_tr_b16 v[46:47], v14 offset:272
    s_waitcnt lgkmcnt(8)
    v_mfma_f32_16x16x32_bf16 v[28:31], v[112:115], v[60:63], v[28:31]
    ds_read_b64 v[84:85], v18 offset:64
    ds_read_b64 v[86:87], v18 offset:72
    ds_read_b64_tr_b16 v[48:49], v16 offset:544
    ds_read_b64_tr_b16 v[50:51], v14 offset:544
    s_waitcnt lgkmcnt(11)
    v_mfma_f32_16x16x32_bf16 v[24:27], v[112:115], v[76:79], v[24:27]
    ds_read_b64 v[124:125], v18 offset:128
    ds_read_b64 v[126:127], v18 offset:136
    v_mfma_f32_16x16x32_bf16 v[28:31], v[116:119], v[76:79], v[28:31]
    s_waitcnt lgkmcnt(12)
    v_mfma_f32_16x16x32_bf16 v[24:27], v[116:119], v[40:43], v[24:27]
    ds_read_b64_tr_b16 v[88:89], v16 offset:816
    ds_read_b64_tr_b16 v[90:91], v14 offset:816
    s_waitcnt lgkmcnt(10)
    v_mfma_f32_16x16x32_bf16 v[24:27], v[120:123], v[80:83], v[24:27]
    ds_read_b64 v[52:53], v18 offset:192
    ds_read_b64 v[54:55], v18 offset:200
    ds_read_b64_tr_b16 v[92:93], v16 offset:1088
    ds_read_b64_tr_b16 v[94:95], v14 offset:1088
    s_waitcnt lgkmcnt(10)
    v_mfma_f32_16x16x32_bf16 v[24:27], v[44:47], v[84:87], v[24:27]
    ds_read_b64 v[2:3], v18 offset:256
    ds_read_b64 v[4:5], v18 offset:264
    ds_read_b64_tr_b16 v[64:65], v16 offset:1360
    ds_read_b64_tr_b16 v[66:67], v14 offset:1360
    s_waitcnt lgkmcnt(10)
    v_mfma_f32_16x16x32_bf16 v[24:27], v[48:51], v[124:127], v[24:27]
    ds_read_b64 v[96:97], v18 offset:320
    ds_read_b64 v[98:99], v18 offset:328
    ds_read_b64_tr_b16 v[32:33], v16 offset:1632
    ds_read_b64_tr_b16 v[34:35], v14 offset:1632
    v_mfma_f32_16x16x32_bf16 v[28:31], v[48:51], v[80:83], v[28:31]
    s_waitcnt lgkmcnt(10)
    v_mfma_f32_16x16x32_bf16 v[24:27], v[88:91], v[52:55], v[24:27]
    ds_read_b64_tr_b16 v[100:101], v16 offset:1904
    ds_read_b64_tr_b16 v[102:103], v14 offset:1904
    ds_read_b64_tr_b16 v[68:69], v17 offset:0
    ds_read_b64_tr_b16 v[70:71], v9 offset:0
    v_mfma_f32_16x16x32_bf16 v[28:31], v[88:91], v[84:87], v[28:31]
    s_waitcnt lgkmcnt(10)
    v_mfma_f32_16x16x32_bf16 v[24:27], v[92:95], v[2:5], v[24:27]
    ds_read2_b32 v[56:57], v19 offset0:48 offset1:49
    ds_read2_b32 v[58:59], v19 offset0:50 offset1:51
    ds_read2_b32 v[104:105], v19 offset0:32 offset1:33
    ds_read2_b32 v[106:107], v19 offset0:34 offset1:35
    v_mfma_f32_16x16x32_bf16 v[28:31], v[92:95], v[124:127], v[28:31]
    s_waitcnt lgkmcnt(10)
    v_mfma_f32_16x16x32_bf16 v[24:27], v[64:67], v[96:99], v[24:27]
    ds_read_b64_tr_b16 v[36:37], v17 offset:544
    ds_read_b64_tr_b16 v[38:39], v9 offset:544
    v_mfma_f32_16x16x32_bf16 v[28:31], v[64:67], v[52:55], v[28:31]
    s_waitcnt lgkmcnt(10)
    v_mfma_f32_16x16x32_bf16 v[28:31], v[32:35], v[2:5], v[28:31]
    s_waitcnt lgkmcnt(8)
    v_mfma_f32_16x16x32_bf16 v[28:31], v[100:103], v[96:99], v[28:31]
    s_waitcnt lgkmcnt(4)
    v_mfma_f32_16x16x32_bf16 v[24:27], v[68:71], v[56:59], v[24:27]
    s_waitcnt lgkmcnt(2)
    v_mfma_f32_16x16x32_bf16 v[28:31], v[68:71], v[104:107], v[28:31]
    s_waitcnt lgkmcnt(0)
    v_mfma_f32_16x16x32_bf16 v[28:31], v[36:39], v[56:59], v[28:31]
    s_nop 7
    v_cvt_pk_bf16_f32 v40, v24, v28
    v_cvt_pk_bf16_f32 v41, v25, v29
    v_cvt_pk_bf16_f32 v42, v26, v30
    v_cvt_pk_bf16_f32 v43, v27, v31
    ds_write_b128 v20, v[40:43]
    s_branch L_Bout
L_conv3:
    ds_read_b128 v[32:35], v13 offset:4064
    ds_read_b128 v[36:39], v13 offset:3552
    ds_read_b128 v[40:43], v13 offset:3040
    ds_read_b128 v[44:47], v13 offset:2528
    ds_read_b128 v[48:51], v13 offset:2016
    ds_read_b128 v[52:55], v13 offset:1504
    s_waitcnt lgkmcnt(5)
    v_mfma_f32_16x16x32_bf16 v[28:31], v[56:59], v[32:35], 0
    ds_read_b128 v[2:5], v13 offset:4000
    ds_read_b128 v[32:35], v13 offset:3488
    s_waitcnt lgkmcnt(6)
    v_mfma_f32_16x16x32_bf16 v[24:27], v[56:59], v[36:39], 0
    ds_read_b128 v[56:59], v13 offset:2976
    v_mfma_f32_16x16x32_bf16 v[28:31], v[60:63], v[36:39], v[28:31]
    ds_read_b128 v[36:39], v13 offset:3936
    s_waitcnt lgkmcnt(7)
    v_mfma_f32_16x16x32_bf16 v[24:27], v[60:63], v[40:43], v[24:27]
    ds_read_b128 v[60:63], v13 offset:3424
    v_mfma_f32_16x16x32_bf16 v[28:31], v[120:123], v[40:43], v[28:31]
    ds_read_b128 v[40:43], v13 offset:2912
    s_waitcnt lgkmcnt(8)
    v_mfma_f32_16x16x32_bf16 v[24:27], v[120:123], v[44:47], v[24:27]
    ds_read_b128 v[120:123], v13 offset:3872
    ds_read_b128 v[44:47], v13 offset:3360
    s_waitcnt lgkmcnt(9)
    v_mfma_f32_16x16x32_bf16 v[28:31], v[124:127], v[48:51], v[28:31]
    ds_read_b128 v[48:51], v13 offset:2848
    s_waitcnt lgkmcnt(9)
    v_mfma_f32_16x16x32_bf16 v[24:27], v[124:127], v[52:55], v[24:27]
    ds_read_b128 v[124:127], v13 offset:3808
    ds_read_b128 v[52:55], v13 offset:3296
    s_waitcnt lgkmcnt(10)
    v_mfma_f32_16x16x32_bf16 v[28:31], v[64:67], v[2:5], v[28:31]
    ds_read_b128 v[2:5], v13 offset:2784
    s_waitcnt lgkmcnt(10)
    v_mfma_f32_16x16x32_bf16 v[24:27], v[64:67], v[32:35], v[24:27]
    ds_read_b128 v[64:67], v13 offset:3744
    v_mfma_f32_16x16x32_bf16 v[28:31], v[68:71], v[32:35], v[28:31]
    ds_read_b128 v[32:35], v13 offset:3232
    s_waitcnt lgkmcnt(11)
    v_mfma_f32_16x16x32_bf16 v[24:27], v[68:71], v[56:59], v[24:27]
    ds_read_b128 v[68:71], v13 offset:2720
    ds_read_b128 v[56:59], v13 offset:3680
    s_waitcnt lgkmcnt(12)
    v_mfma_f32_16x16x32_bf16 v[28:31], v[72:75], v[36:39], v[28:31]
    ds_read_b128 v[36:39], v13 offset:3168
    s_waitcnt lgkmcnt(12)
    v_mfma_f32_16x16x32_bf16 v[24:27], v[72:75], v[60:63], v[24:27]
    ds_read_b128 v[72:75], v13 offset:2656
    v_mfma_f32_16x16x32_bf16 v[28:31], v[76:79], v[60:63], v[28:31]
    s_waitcnt lgkmcnt(12)
    v_mfma_f32_16x16x32_bf16 v[24:27], v[76:79], v[40:43], v[24:27]
    ds_read_b128 v[60:63], v13 offset:3616
    s_waitcnt lgkmcnt(12)
    v_mfma_f32_16x16x32_bf16 v[28:31], v[80:83], v[120:123], v[28:31]
    ds_read_b128 v[76:79], v13 offset:3104
    s_waitcnt lgkmcnt(12)
    v_mfma_f32_16x16x32_bf16 v[24:27], v[80:83], v[44:47], v[24:27]
    ds_read_b128 v[40:43], v13 offset:2592
    v_mfma_f32_16x16x32_bf16 v[28:31], v[84:87], v[44:47], v[28:31]
    s_waitcnt lgkmcnt(12)
    v_mfma_f32_16x16x32_bf16 v[24:27], v[84:87], v[48:51], v[24:27]
    s_waitcnt lgkmcnt(11)
    v_mfma_f32_16x16x32_bf16 v[28:31], v[88:91], v[124:127], v[28:31]
    s_waitcnt lgkmcnt(10)
    v_mfma_f32_16x16x32_bf16 v[24:27], v[88:91], v[52:55], v[24:27]
    v_mfma_f32_16x16x32_bf16 v[28:31], v[92:95], v[52:55], v[28:31]
    s_waitcnt lgkmcnt(9)
    v_mfma_f32_16x16x32_bf16 v[24:27], v[92:95], v[2:5], v[24:27]
    s_waitcnt lgkmcnt(8)
    v_mfma_f32_16x16x32_bf16 v[28:31], v[96:99], v[64:67], v[28:31]
    s_waitcnt lgkmcnt(7)
    v_mfma_f32_16x16x32_bf16 v[24:27], v[96:99], v[32:35], v[24:27]
    v_mfma_f32_16x16x32_bf16 v[28:31], v[100:103], v[32:35], v[28:31]
    s_waitcnt lgkmcnt(6)
    v_mfma_f32_16x16x32_bf16 v[24:27], v[100:103], v[68:71], v[24:27]
    s_waitcnt lgkmcnt(5)
    v_mfma_f32_16x16x32_bf16 v[28:31], v[104:107], v[56:59], v[28:31]
    s_waitcnt lgkmcnt(4)
    v_mfma_f32_16x16x32_bf16 v[24:27], v[104:107], v[36:39], v[24:27]
    v_mfma_f32_16x16x32_bf16 v[28:31], v[108:111], v[36:39], v[28:31]
    s_waitcnt lgkmcnt(3)
    v_mfma_f32_16x16x32_bf16 v[24:27], v[108:111], v[72:75], v[24:27]
    s_barrier
    ds_read_b64_tr_b16 v[120:121], v16 offset:1088
    ds_read_b64_tr_b16 v[122:123], v14 offset:1088
    ds_read_b64 v[80:81], v18 offset:0
    ds_read_b64 v[82:83], v18 offset:8
    ds_read_b64_tr_b16 v[44:45], v16 offset:1360
    ds_read_b64_tr_b16 v[46:47], v14 offset:1360
    s_waitcnt lgkmcnt(8)
    v_mfma_f32_16x16x32_bf16 v[28:31], v[112:115], v[60:63], v[28:31]
    ds_read_b64 v[84:85], v18 offset:64
    ds_read_b64 v[86:87], v18 offset:72
    ds_read_b64_tr_b16 v[48:49], v16 offset:1632
    ds_read_b64_tr_b16 v[50:51], v14 offset:1632
    s_waitcnt lgkmcnt(11)
    v_mfma_f32_16x16x32_bf16 v[24:27], v[112:115], v[76:79], v[24:27]
    ds_read_b64 v[124:125], v18 offset:128
    ds_read_b64 v[126:127], v18 offset:136
    v_mfma_f32_16x16x32_bf16 v[28:31], v[116:119], v[76:79], v[28:31]
    s_waitcnt lgkmcnt(12)
    v_mfma_f32_16x16x32_bf16 v[24:27], v[116:119], v[40:43], v[24:27]
    ds_read_b64_tr_b16 v[88:89], v16 offset:1904
    ds_read_b64_tr_b16 v[90:91], v14 offset:1904
    s_waitcnt lgkmcnt(10)
    v_mfma_f32_16x16x32_bf16 v[24:27], v[120:123], v[80:83], v[24:27]
    ds_read_b64 v[52:53], v18 offset:192
    ds_read_b64 v[54:55], v18 offset:200
    ds_read_b64_tr_b16 v[92:93], v16 offset:2176
    ds_read_b64_tr_b16 v[94:95], v14 offset:2176
    s_waitcnt lgkmcnt(10)
    v_mfma_f32_16x16x32_bf16 v[24:27], v[44:47], v[84:87], v[24:27]
    ds_read_b64 v[2:3], v18 offset:256
    ds_read_b64 v[4:5], v18 offset:264
    ds_read_b64_tr_b16 v[64:65], v16 offset:2448
    ds_read_b64_tr_b16 v[66:67], v14 offset:2448
    s_waitcnt lgkmcnt(10)
    v_mfma_f32_16x16x32_bf16 v[24:27], v[48:51], v[124:127], v[24:27]
    ds_read_b64 v[96:97], v18 offset:320
    ds_read_b64 v[98:99], v18 offset:328
    ds_read_b64_tr_b16 v[32:33], v16 offset:2720
    ds_read_b64_tr_b16 v[34:35], v14 offset:2720
    v_mfma_f32_16x16x32_bf16 v[28:31], v[48:51], v[80:83], v[28:31]
    s_waitcnt lgkmcnt(10)
    v_mfma_f32_16x16x32_bf16 v[24:27], v[88:91], v[52:55], v[24:27]
    ds_read_b64_tr_b16 v[100:101], v16 offset:2992
    ds_read_b64_tr_b16 v[102:103], v14 offset:2992
    ds_read_b64_tr_b16 v[68:69], v17 offset:0
    ds_read_b64_tr_b16 v[70:71], v9 offset:0
    v_mfma_f32_16x16x32_bf16 v[28:31], v[88:91], v[84:87], v[28:31]
    s_waitcnt lgkmcnt(10)
    v_mfma_f32_16x16x32_bf16 v[24:27], v[92:95], v[2:5], v[24:27]
    ds_read2_b32 v[56:57], v19 offset0:16 offset1:17
    ds_read2_b32 v[58:59], v19 offset0:18 offset1:19
    ds_read2_b32 v[104:105], v19 offset0:0 offset1:1
    ds_read2_b32 v[106:107], v19 offset0:2 offset1:3
    v_mfma_f32_16x16x32_bf16 v[28:31], v[92:95], v[124:127], v[28:31]
    s_waitcnt lgkmcnt(10)
    v_mfma_f32_16x16x32_bf16 v[24:27], v[64:67], v[96:99], v[24:27]
    ds_read_b64_tr_b16 v[36:37], v17 offset:544
    ds_read_b64_tr_b16 v[38:39], v9 offset:544
    ds_read2_b32 v[108:109], v19 offset0:32 offset1:33
    ds_read2_b32 v[110:111], v19 offset0:34 offset1:35
    v_mfma_f32_16x16x32_bf16 v[28:31], v[64:67], v[52:55], v[28:31]
    s_waitcnt lgkmcnt(12)
    v_mfma_f32_16x16x32_bf16 v[28:31], v[32:35], v[2:5], v[28:31]
    ds_read_b64_tr_b16 v[72:73], v17 offset:1088
    ds_read_b64_tr_b16 v[74:75], v9 offset:1088
    s_waitcnt lgkmcnt(12)
    v_mfma_f32_16x16x32_bf16 v[28:31], v[100:103], v[96:99], v[28:31]
    ds_read2_b32 v[60:61], v19 offset0:48 offset1:49
    ds_read2_b32 v[62:63], v19 offset0:50 offset1:51
    s_waitcnt lgkmcnt(10)
    v_mfma_f32_16x16x32_bf16 v[24:27], v[68:71], v[56:59], v[24:27]
    ds_read_b64_tr_b16 v[112:113], v17 offset:1632
    ds_read_b64_tr_b16 v[114:115], v9 offset:1632
    s_waitcnt lgkmcnt(10)
    v_mfma_f32_16x16x32_bf16 v[28:31], v[68:71], v[104:107], v[28:31]
    s_waitcnt lgkmcnt(6)
    v_mfma_f32_16x16x32_bf16 v[24:27], v[36:39], v[108:111], v[24:27]
    v_mfma_f32_16x16x32_bf16 v[28:31], v[36:39], v[56:59], v[28:31]
    s_waitcnt lgkmcnt(2)
    v_mfma_f32_16x16x32_bf16 v[24:27], v[72:75], v[60:63], v[24:27]
    v_mfma_f32_16x16x32_bf16 v[28:31], v[72:75], v[108:111], v[28:31]
    s_waitcnt lgkmcnt(0)
    v_mfma_f32_16x16x32_bf16 v[28:31], v[112:115], v[60:63], v[28:31]
    s_nop 7
    v_cvt_pk_bf16_f32 v40, v24, v28
    v_cvt_pk_bf16_f32 v41, v25, v29
    v_cvt_pk_bf16_f32 v42, v26, v30
    v_cvt_pk_bf16_f32 v43, v27, v31
    ds_write_b128 v20, v[40:43]
L_Bout:
    s_waitcnt lgkmcnt(0)
    s_barrier
    ds_read2st64_b32 v[32:33], v21 offset0:0 offset1:136
    ds_read2st64_b32 v[34:35], v21 offset0:34 offset1:170
    s_waitcnt lgkmcnt(0)
    buffer_store_dwordx4 v[32:35], v22, s[28:31], s54 offen sc1
    s_endpgm
L_end:
    s_endpgm
L_code_end:
.p2align 7
.type k_tables,@object
k_tables:
.long 0x6d10,0x7840,0x11200,0x12410,0x4ad0,0x7848,0x12810,0x11600,0x2890,0x7850,0x11a00,0x12c10,0x650,0x7858,0x13010,0x11e00
.long 0x6710,0x5680,0x11220,0x12430,0x44d0,0x5688,0x12830,0x11620,0x2290,0x5690,0x11a20,0x12c30,0x50,0x5698,0x13030,0x11e20
.long 0x6d00,0x7860,0x11240,0x12450,0x4ac0,0x7868,0x12850,0x11640,0x2880,0x7870,0x11a40,0x12c50,0x640,0x7878,0x13050,0x11e40
.long 0x6700,0x56a0,0x11260,0x12470,0x44c0,0x56a8,0x12870,0x11660,0x2280,0x56b8,0x11a60,0x12c70,0x40,0x56c0,0x13070,0x11e60
.long 0x6d20,0x78c8,0x11204,0x12414,0x4ae0,0x78d0,0x12814,0x11604,0x28a0,0x78d8,0x11a04,0x12c14,0x660,0x78e0,0x13014,0x11e04
.long 0x6720,0x5708,0x11224,0x12434,0x44e0,0x5710,0x12834,0x11624,0x22a0,0x5718,0x11a24,0x12c34,0x60,0x5720,0x13034,0x11e24
.long 0x6d10,0x78e8,0x11244,0x12454,0x4ad0,0x78f0,0x12854,0x11644,0x2890,0x78f8,0x11a44,0x12c54,0x650,0x7900,0x13054,0x11e44
.long 0x6710,0x5728,0x11264,0x12474,0x44d0,0x5730,0x12874,0x11664,0x2290,0x5740,0x11a64,0x12c74,0x50,0x5748,0x13074,0x11e64
.long 0x6d30,0x7950,0x11208,0x12418,0x4af0,0x7958,0x12818,0x11608,0x28b0,0x7960,0x11a08,0x12c18,0x670,0x7968,0x13018,0x11e08
.long 0x6730,0x5790,0x11228,0x12438,0x44f0,0x5798,0x12838,0x11628,0x22b0,0x57a0,0x11a28,0x12c38,0x70,0x57a8,0x13038,0x11e28
.long 0x6d20,0x7970,0x11248,0x12458,0x4ae0,0x7978,0x12858,0x11648,0x28a0,0x7980,0x11a48,0x12c58,0x660,0x7988,0x13058,0x11e48
.long 0x6720,0x57b0,0x11268,0x12478,0x44e0,0x57b8,0x12878,0x11668,0x22a0,0x57c8,0x11a68,0x12c78,0x60,0x57d0,0x13078,0x11e68
.long 0x6d40,0x79d8,0x1120c,0x1241c,0x4b00,0x79e0,0x1281c,0x1160c,0x28c0,0x79e8,0x11a0c,0x12c1c,0x680,0x79f0,0x1301c,0x11e0c
.long 0x6740,0x5818,0x1122c,0x1243c,0x4500,0x5820,0x1283c,0x1162c,0x22c0,0x5828,0x11a2c,0x12c3c,0x80,0x5830,0x1303c,0x11e2c
.long 0x6d30,0x79f8,0x1124c,0x1245c,0x4af0,0x7a00,0x1285c,0x1164c,0x28b0,0x7a08,0x11a4c,0x12c5c,0x670,0x7a10,0x1305c,0x11e4c
.long 0x6730,0x5838,0x1126c,0x1247c,0x44f0,0x5840,0x1287c,0x1166c,0x22b0,0x5850,0x11a6c,0x12c7c,0x70,0x5858,0x1307c,0x11e6c
.long 0x5040100,0x11000,0x3420,0x1218,0x7060302,0x11020,0x3428,0x1238,0x5040100,0x11040,0x3430,0x1258,0x7060302,0x11060,0x3438,0x1278
.long 0x5040100,0x11080,0x12a8,0x12a0,0x7060302,0x110a0,0x12b0,0x12c0,0x5040100,0x110c0,0x12b8,0x12e0,0x7060302,0x110e0,0x12c0,0x1300
.long 0x5040100,0x11100,0x3430,0x1328,0x7060302,0x11120,0x3438,0x1348,0x5040100,0x11140,0x3440,0x1368,0x7060302,0x11160,0x3448,0x1388
.long 0x5040100,0x11180,0x12b8,0x13b0,0x7060302,0x111a0,0x12c0,0x13d0,0x5040100,0x111c0,0x12c8,0x13f0,0x7060302,0x111e0,0x12d0,0x1410
.long 0x5040100,0x11010,0x3460,0x1220,0x7060302,0x11030,0x3468,0x1240,0x5040100,0x11050,0x3470,0x1260,0x7060302,0x11070,0x3478,0x1288
.long 0x5040100,0x11090,0x12e8,0x12a8,0x7060302,0x110b0,0x12f0,0x12c8,0x5040100,0x110d0,0x12f8,0x12e8,0x7060302,0x110f0,0x1308,0x1310
.long 0x5040100,0x11110,0x3470,0x1330,0x7060302,0x11130,0x3478,0x1350,0x5040100,0x11150,0x3488,0x1370,0x7060302,0x11170,0x3490,0x1398
.long 0x5040100,0x11190,0x12f8,0x13b8,0x7060302,0x111b0,0x1308,0x13d8,0x5040100,0x111d0,0x1310,0x13f8,0x7060302,0x111f0,0x1318,0x1420
.long 0x5040100,0x11020,0x34a8,0x1228,0x7060302,0x11040,0x34b0,0x1248,0x5040100,0x11060,0x34b8,0x1268,0x7060302,0x11080,0x34c0,0x1290
.long 0x5040100,0x110a0,0x1330,0x12b0,0x7060302,0x110c0,0x1338,0x12d0,0x5040100,0x110e0,0x1340,0x12f0,0x7060302,0x11100,0x1348,0x1318
.long 0x5040100,0x11120,0x34b8,0x1338,0x7060302,0x11140,0x34c0,0x1358,0x5040100,0x11160,0x34c8,0x1378,0x7060302,0x11180,0x34d0,0x13a0
.long 0x5040100,0x111a0,0x1340,0x13c0,0x7060302,0x111c0,0x1348,0x13e0,0x5040100,0x111e0,0x1350,0x1400,0x7060302,0x11200,0x1358,0x1428
.long 0x5040100,0x11030,0x34e8,0x1230,0x7060302,0x11050,0x34f0,0x1250,0x5040100,0x11070,0x34f8,0x1270,0x7060302,0x11090,0x3500,0x1298
.long 0x5040100,0x110b0,0x1370,0x12b8,0x7060302,0x110d0,0x1378,0x12d8,0x5040100,0x110f0,0x1380,0x12f8,0x7060302,0x11110,0x1390,0x1320
.long 0x5040100,0x11130,0x34f8,0x1340,0x7060302,0x11150,0x3500,0x1360,0x5040100,0x11170,0x3510,0x1380,0x7060302,0x11190,0x3518,0x13a8
.long 0x5040100,0x111b0,0x1380,0x13c8,0x7060302,0x111d0,0x1390,0x13e8,0x5040100,0x111f0,0x1398,0x1408,0x7060302,0x11210,0x13a0,0x1430
.long 0x3400,0x7800,0x13498,0x1385c,0x3408,0x7808,0x13490,0x13858,0x3410,0x7810,0x13488,0x13854,0x3418,0x7818,0x13480,0x13850
.long 0x1288,0x5640,0x13478,0x1384c,0x1290,0x5648,0x13470,0x13848,0x1298,0x5650,0x13468,0x13844,0x12a0,0x5658,0x13460,0x13840
.long 0x3410,0x7820,0x13458,0x1383c,0x3418,0x7828,0x13450,0x13838,0x3420,0x7830,0x13448,0x13834,0x3428,0x7838,0x13440,0x13830
.long 0x1298,0x5660,0x13438,0x1382c,0x12a0,0x5668,0x13430,0x13828,0x12a8,0x5670,0x13428,0x13824,0x12b0,0x5678,0x13420,0x13820
.long 0x3440,0x7888,0x134a8,0x1386c,0x3448,0x7890,0x134a0,0x13868,0x3450,0x7898,0x13498,0x13864,0x3458,0x78a0,0x13490,0x13860
.long 0x12c8,0x56c8,0x13488,0x1385c,0x12d0,0x56d0,0x13480,0x13858,0x12d8,0x56d8,0x13478,0x13854,0x12e0,0x56e0,0x13470,0x13850
.long 0x3450,0x78a8,0x13468,0x1384c,0x3458,0x78b0,0x13460,0x13848,0x3460,0x78b8,0x13458,0x13844,0x3468,0x78c0,0x13450,0x13840
.long 0x12d8,0x56e8,0x13448,0x1383c,0x12e0,0x56f0,0x13440,0x13838,0x12e8,0x56f8,0x13438,0x13834,0x12f0,0x5700,0x13430,0x13830
.long 0x3488,0x7910,0x134b8,0x1387c,0x3490,0x7918,0x134b0,0x13878,0x3498,0x7920,0x134a8,0x13874,0x34a0,0x7928,0x134a0,0x13870
.long 0x1310,0x5750,0x13498,0x1386c,0x1318,0x5758,0x13490,0x13868,0x1320,0x5760,0x13488,0x13864,0x1328,0x5768,0x13480,0x13860
.long 0x3498,0x7930,0x13478,0x1385c,0x34a0,0x7938,0x13470,0x13858,0x34a8,0x7940,0x13468,0x13854,0x34b0,0x7948,0x13460,0x13850
.long 0x1320,0x5770,0x13458,0x1384c,0x1328,0x5778,0x13450,0x13848,0x1330,0x5780,0x13448,0x13844,0x1338,0x5788,0x13440,0x13840
.long 0x34c8,0x7998,0x134c8,0x1388c,0x34d0,0x79a0,0x134c0,0x13888,0x34d8,0x79a8,0x134b8,0x13884,0x34e0,0x79b0,0x134b0,0x13880
.long 0x1350,0x57d8,0x134a8,0x1387c,0x1358,0x57e0,0x134a0,0x13878,0x1360,0x57e8,0x13498,0x13874,0x1368,0x57f0,0x13490,0x13870
.long 0x34d8,0x79b8,0x13488,0x1386c,0x34e0,0x79c0,0x13480,0x13868,0x34e8,0x79c8,0x13478,0x13864,0x34f0,0x79d0,0x13470,0x13860
.long 0x1360,0x57f8,0x13468,0x1385c,0x1368,0x5800,0x13460,0x13858,0x1370,0x5808,0x13458,0x13854,0x1378,0x5810,0x13450,0x13850
.long 0x11000,0xc80,0x0,0x7060302,0x11010,0x50c0,0x10,0x5040100,0x11020,0xc84,0x20,0x7060302,0x11030,0x50c4,0x30,0x5040100
.long 0x11040,0xc90,0x40,0x7060302,0x11050,0x50d0,0x50,0x5040100,0x11060,0xc94,0x60,0x7060302,0x11070,0x50d4,0x70,0x5040100
.long 0x11080,0xca0,0x80,0x7060302,0x11090,0x50e0,0x90,0x5040100,0x110a0,0xca4,0xa0,0x7060302,0x110b0,0x50e4,0xb0,0x5040100
.long 0x110c0,0xcb0,0xc0,0x7060302,0x110d0,0x50f0,0xd0,0x5040100,0x110e0,0xcb4,0xe0,0x7060302,0x110f0,0x50f4,0xf0,0x5040100
.long 0x11100,0xc88,0x100,0x7060302,0x11110,0x50c8,0x110,0x5040100,0x11120,0xc8c,0x120,0x7060302,0x11130,0x50cc,0x130,0x5040100
.long 0x11140,0xc98,0x140,0x7060302,0x11150,0x50d8,0x150,0x5040100,0x11160,0xc9c,0x160,0x7060302,0x11170,0x50dc,0x170,0x5040100
.long 0x11180,0xca8,0x180,0x7060302,0x11190,0x50e8,0x190,0x5040100,0x111a0,0xcac,0x1a0,0x7060302,0x111b0,0x50ec,0x1b0,0x5040100
.long 0x111c0,0xcb8,0x1c0,0x7060302,0x111d0,0x50f8,0x1d0,0x5040100,0x111e0,0xcbc,0x1e0,0x7060302,0x111f0,0x50fc,0x1f0,0x5040100
.long 0x12210,0xd80,0x200,0x7060302,0x12220,0x51c0,0x210,0x5040100,0x12230,0xd84,0x220,0x7060302,0x12240,0x51c4,0x230,0x5040100
.long 0x12250,0xd90,0x240,0x7060302,0x12260,0x51d0,0x250,0x5040100,0x12270,0xd94,0x260,0x7060302,0x12280,0x51d4,0x270,0x5040100
.long 0x12290,0xda0,0x280,0x7060302,0x122a0,0x51e0,0x290,0x5040100,0x122b0,0xda4,0x2a0,0x7060302,0x122c0,0x51e4,0x2b0,0x5040100
.long 0x122d0,0xdb0,0x2c0,0x7060302,0x122e0,0x51f0,0x2d0,0x5040100,0x122f0,0xdb4,0x2e0,0x7060302,0x12300,0x51f4,0x2f0,0x5040100
.long 0x12310,0xd88,0x300,0x7060302,0x12320,0x51c8,0x310,0x5040100,0x12330,0xd8c,0x320,0x7060302,0x12340,0x51cc,0x330,0x5040100
.long 0x12350,0xd98,0x340,0x7060302,0x12360,0x51d8,0x350,0x5040100,0x12370,0xd9c,0x360,0x7060302,0x12380,0x51dc,0x370,0x5040100
.long 0x12390,0xda8,0x380,0x7060302,0x123a0,0x51e8,0x390,0x5040100,0x123b0,0xdac,0x3a0,0x7060302,0x123c0,0x51ec,0x3b0,0x5040100
.long 0x123d0,0xdb8,0x3c0,0x7060302,0x123e0,0x51f8,0x3d0,0x5040100,0x123f0,0xdbc,0x3e0,0x7060302,0x12400,0x51fc,0x3f0,0x5040100
.long 0x1950,0x0,0x0,0x540,0x1860,0x0,0x0,0x518,0x1960,0x0,0x0,0x510,0x1870,0x0,0x0,0x508
.long 0x1970,0x0,0x0,0x500,0x21f0,0xffff,0x0,0x4f8,0x21f0,0x0,0xffff0000,0x4f0,0x1890,0x0,0x0,0x4e8
.long 0x1990,0x0,0x0,0x4e0,0x18a0,0x0,0x0,0x4d8,0x19a0,0x0,0x0,0x4d0,0x18b0,0x0,0x0,0x4c8
.long 0x19b0,0x0,0x0,0x4c0,0x18c0,0x0,0x0,0x4b8,0x19c0,0x0,0x0,0x4b0,0x18d0,0x0,0x0,0x4a8
.long 0x18d0,0x0,0x0,0x540,0x19d0,0x0,0x0,0x4a0,0x18e0,0x0,0x0,0x498,0x19e0,0x0,0x0,0x490
.long 0x18f0,0x0,0x0,0x488,0x19f0,0x0,0x0,0x480,0x1200,0xffffffff,0xffffffff,0x478,0x1300,0xffffffff,0xffffffff,0x470
.long 0x1210,0xffffffff,0xffffffff,0x468,0x1310,0xffffffff,0xffffffff,0x460,0x1220,0xffffffff,0xffffffff,0x458,0x1320,0xffffffff,0xffffffff,0x450
.long 0x1230,0xffffffff,0xffffffff,0x448,0x1330,0xffffffff,0xffffffff,0x440,0x1240,0xffffffff,0xffffffff,0x438,0x1340,0xffffffff,0xffffffff,0x430
.long 0x1340,0xffffffff,0xffffffff,0x540,0x1250,0xffffffff,0xffffffff,0x428,0x1350,0xffffffff,0xffffffff,0x420,0x1260,0xffffffff,0xffffffff,0x418
.long 0x1360,0xffffffff,0xffffffff,0x410,0x1270,0xffffffff,0xffffffff,0x408,0x1370,0xffffffff,0xffffffff,0x400,0x1280,0xffffffff,0xffffffff,0x3f8
.long 0x1380,0xffffffff,0xffffffff,0x3f0,0x1290,0xffffffff,0xffffffff,0x3e8,0x1390,0xffffffff,0xffffffff,0x3e0,0x12a0,0xffffffff,0xffffffff,0x3d8
.long 0x13a0,0xffffffff,0xffffffff,0x3d0,0x12b0,0xffffffff,0xffffffff,0x3c8,0x13b0,0xffffffff,0xffffffff,0x3c0,0x12c0,0xffffffff,0xffffffff,0x3b8
.long 0x12c0,0xffffffff,0xffffffff,0x540,0x13c0,0xffffffff,0xffffffff,0x3b0,0x12d0,0xffffffff,0xffffffff,0x3a8,0x13d0,0xffffffff,0xffffffff,0x3a0
.long 0x12e0,0xffffffff,0xffffffff,0x398,0x13e0,0xffffffff,0xffffffff,0x390,0x12f0,0xffffffff,0xffffffff,0x388,0x13f0,0xffffffff,0xffffffff,0x380
.long 0x1600,0xffffffff,0xffffffff,0x378,0x1700,0xffffffff,0xffffffff,0x370,0x1610,0xffffffff,0xffffffff,0x368,0x1710,0xffffffff,0xffffffff,0x360
.long 0x1620,0xffffffff,0xffffffff,0x358,0x1720,0xffffffff,0xffffffff,0x350,0x1630,0xffffffff,0xffffffff,0x348,0x1730,0xffffffff,0xffffffff,0x340
.long 0x1730,0xffffffff,0xffffffff,0x540,0x1640,0xffffffff,0xffffffff,0x338,0x1740,0xffffffff,0xffffffff,0x330,0x1650,0xffffffff,0xffffffff,0x328
.long 0x1750,0xffffffff,0xffffffff,0x320,0x1660,0xffffffff,0xffffffff,0x318,0x1760,0xffffffff,0xffffffff,0x310,0x1670,0xffffffff,0xffffffff,0x308
.long 0x1770,0xffffffff,0xffffffff,0x300,0x1680,0xffffffff,0xffffffff,0x2f8,0x1780,0xffffffff,0xffffffff,0x2f0,0x1690,0xffffffff,0xffffffff,0x2e8
.long 0x1790,0xffffffff,0xffffffff,0x2e0,0x16a0,0xffffffff,0xffffffff,0x2d8,0x17a0,0xffffffff,0xffffffff,0x2d0,0x16b0,0xffffffff,0xffffffff,0x2c8
.long 0x16b0,0xffffffff,0xffffffff,0x540,0x17b0,0xffffffff,0xffffffff,0x2c0,0x16c0,0xffffffff,0xffffffff,0x2b8,0x17c0,0xffffffff,0xffffffff,0x2b0
.long 0x16d0,0xffffffff,0xffffffff,0x2a8,0x17d0,0xffffffff,0xffffffff,0x2a0,0x16e0,0xffffffff,0xffffffff,0x298,0x17e0,0xffffffff,0xffffffff,0x290
.long 0x16f0,0xffffffff,0xffffffff,0x288,0x17f0,0xffffffff,0xffffffff,0x280,0x1400,0xffffffff,0xffffffff,0x278,0x1500,0xffffffff,0xffffffff,0x270
.long 0x1410,0xffffffff,0xffffffff,0x268,0x1510,0xffffffff,0xffffffff,0x260,0x1420,0xffffffff,0xffffffff,0x258,0x1520,0xffffffff,0xffffffff,0x250
.long 0x1520,0xffffffff,0xffffffff,0x540,0x1430,0xffffffff,0xffffffff,0x248,0x1530,0xffffffff,0xffffffff,0x240,0x1440,0xffffffff,0xffffffff,0x238
.long 0x1540,0xffffffff,0xffffffff,0x230,0x1450,0xffffffff,0xffffffff,0x228,0x1550,0xffffffff,0xffffffff,0x220,0x1460,0xffffffff,0xffffffff,0x218
.long 0x1560,0xffffffff,0xffffffff,0x210,0x1470,0xffffffff,0xffffffff,0x208,0x1570,0xffffffff,0xffffffff,0x200,0x1480,0xffffffff,0xffffffff,0x1f8
.long 0x1580,0xffffffff,0xffffffff,0x1f0,0x1490,0xffffffff,0xffffffff,0x1e8,0x1590,0xffffffff,0xffffffff,0x1e0,0x14a0,0xffffffff,0xffffffff,0x1d8
.long 0x14a0,0xffffffff,0xffffffff,0x540,0x15a0,0xffffffff,0xffffffff,0x1d0,0x14b0,0xffffffff,0xffffffff,0x1c8,0x15b0,0xffffffff,0xffffffff,0x1c0
.long 0x14c0,0xffffffff,0xffffffff,0x1b8,0x15c0,0xffffffff,0xffffffff,0x1b0,0x14d0,0xffffffff,0xffffffff,0x1a8,0x15d0,0xffffffff,0xffffffff,0x1a0
.long 0x14e0,0xffffffff,0xffffffff,0x198,0x15e0,0xffffffff,0xffffffff,0x190,0x14f0,0xffffffff,0xffffffff,0x188,0x15f0,0xffffffff,0xffffffff,0x180
.long 0x1800,0xffffffff,0xffffffff,0x178,0x1900,0xffffffff,0xffffffff,0x170,0x1810,0xffffffff,0xffffffff,0x168,0x1910,0xffffffff,0xffffffff,0x160
.long 0x1910,0xffffffff,0xffffffff,0x540,0x1820,0xffffffff,0xffffffff,0x158,0x1920,0xffffffff,0xffffffff,0x150,0x1830,0xffffffff,0xffffffff,0x148
.long 0x1930,0xffffffff,0xffffffff,0x140,0x1840,0xffffffff,0xffffffff,0x138,0x1940,0xffffffff,0xffffffff,0x130,0x1850,0xffffffff,0xffffffff,0x128
.long 0x1950,0xffffffff,0xffffffff,0x120,0x1860,0xffffffff,0xffffffff,0x118,0x1960,0xffffffff,0xffffffff,0x110,0x1870,0xffffffff,0xffffffff,0x108
.long 0x1970,0xffffffff,0xffffffff,0x100,0x1880,0xffffffff,0xffffffff,0xf8,0x1980,0xffffffff,0xffffffff,0xf0,0x1890,0xffffffff,0xffffffff,0xe8
.long 0x1890,0xffffffff,0xffffffff,0x540,0x1990,0xffffffff,0xffffffff,0xe0,0x18a0,0xffffffff,0xffffffff,0xd8,0x19a0,0xffffffff,0xffffffff,0xd0
.long 0x18b0,0xffffffff,0xffffffff,0xc8,0x19b0,0xffffffff,0xffffffff,0xc0,0x18c0,0xffffffff,0xffffffff,0xb8,0x19c0,0xffffffff,0xffffffff,0xb0
.long 0x18d0,0xffffffff,0xffffffff,0xa8,0x19d0,0xffffffff,0xffffffff,0xa0,0x18e0,0xffffffff,0xffffffff,0x98,0x19e0,0xffffffff,0xffffffff,0x90
.long 0x18f0,0xffffffff,0xffffffff,0x88,0x19f0,0xffffffff,0xffffffff,0x80,0x1c00,0xffff0000,0xffffffff,0x78,0x1300,0x0,0x0,0x70
.long 0x1300,0x0,0x0,0x540,0x1210,0x0,0x0,0x68,0x1310,0x0,0x0,0x60,0x1220,0x0,0x0,0x58
.long 0x1320,0x0,0x0,0x50,0x1230,0x0,0x0,0x48,0x1330,0x0,0x0,0x40,0x1240,0x0,0x0,0x540
.long 0x1340,0x0,0x0,0x540,0x1250,0x0,0x0,0x540,0x1350,0x0,0x0,0x540,0x1260,0x0,0x0,0x540
.long 0x1360,0x0,0x0,0x540,0x1270,0x0,0x0,0x540,0x1370,0x0,0x0,0x540,0x1280,0x0,0x0,0x540
.long 0x1280,0x0,0x0,0x540,0x1380,0x0,0x0,0x540,0x1290,0x0,0x0,0x540,0x1390,0x0,0x0,0x540
.long 0x12a0,0x0,0x0,0x540,0x13a0,0x0,0x0,0x540,0x12b0,0x0,0x0,0x540,0x13b0,0x0,0x0,0x540
.long 0x12c0,0x0,0x0,0x540,0x13c0,0x0,0x0,0x540,0x12d0,0x0,0x0,0x540,0x13d0,0x0,0x0,0x540
.long 0x12e0,0x0,0x0,0x540,0x13e0,0x0,0x0,0x540,0x12f0,0x0,0x0,0x540,0x13f0,0x0,0x0,0x540
.long 0x1a00,0x1351c,0x1385e,0x0,0x1a10,0x13518,0x1385c,0x0,0x1a20,0x13514,0x1385a,0x0,0x1a30,0x13510,0x13858,0x0
.long 0x1a40,0x1350c,0x13856,0x0,0x1a50,0x13508,0x13854,0x0,0x1a60,0x13504,0x13852,0x0,0x1a70,0x13500,0x13850,0x0
.long 0x1a80,0x134fc,0x1384e,0x0,0x1a90,0x134f8,0x1384c,0x0,0x1aa0,0x134f4,0x1384a,0x0,0x1ab0,0x134f0,0x13848,0x0
.long 0x1ac0,0x134ec,0x13846,0x0,0x1ad0,0x134e8,0x13844,0x0,0x1ae0,0x134e4,0x13842,0x0,0x1af0,0x134e0,0x13840,0x0
.long 0x1e00,0x134dc,0x1383e,0x0,0x1e10,0x134d8,0x1383c,0x0,0x1e20,0x134d4,0x1383a,0x0,0x1e30,0x134d0,0x13838,0x0
.long 0x1e40,0x134cc,0x13836,0x0,0x1e50,0x134c8,0x13834,0x0,0x1e60,0x134c4,0x13832,0x0,0x1e70,0x134c0,0x13830,0x0
.long 0x1e80,0x134bc,0x1382e,0x0,0x1e90,0x134b8,0x1382c,0x0,0x1ea0,0x134b4,0x1382a,0x0,0x1eb0,0x134b0,0x13828,0x0
.long 0x1ec0,0x134ac,0x13826,0x0,0x1ed0,0x134a8,0x13824,0x0,0x1ee0,0x134a4,0x13822,0x0,0x1ef0,0x134a0,0x13820,0x0
.long 0x1b00,0x1351c,0x1385e,0x0,0x1b10,0x13518,0x1385c,0x0,0x1b20,0x13514,0x1385a,0x0,0x1b30,0x13510,0x13858,0x0
.long 0x1b40,0x1350c,0x13856,0x0,0x1b50,0x13508,0x13854,0x0,0x1b60,0x13504,0x13852,0x0,0x1b70,0x13500,0x13850,0x0
.long 0x1b80,0x134fc,0x1384e,0x0,0x1b90,0x134f8,0x1384c,0x0,0x1ba0,0x134f4,0x1384a,0x0,0x1bb0,0x134f0,0x13848,0x0
.long 0x1bc0,0x134ec,0x13846,0x0,0x1bd0,0x134e8,0x13844,0x0,0x1be0,0x134e4,0x13842,0x0,0x1bf0,0x134e0,0x13840,0x0
.long 0x1f00,0x134dc,0x1383e,0x0,0x1f10,0x134d8,0x1383c,0x0,0x1f20,0x134d4,0x1383a,0x0,0x1f30,0x134d0,0x13838,0x0
.long 0x1f40,0x134cc,0x13836,0x0,0x1f50,0x134c8,0x13834,0x0,0x1f60,0x134c4,0x13832,0x0,0x1f70,0x134c0,0x13830,0x0
.long 0x1f80,0x134bc,0x1382e,0x0,0x1f90,0x134b8,0x1382c,0x0,0x1fa0,0x134b4,0x1382a,0x0,0x1fb0,0x134b0,0x13828,0x0
.long 0x1fc0,0x134ac,0x13826,0x0,0x1fd0,0x134a8,0x13824,0x0,0x1fe0,0x134a4,0x13822,0x0,0x1ff0,0x134a0,0x13820,0x0
.long 0x0,0x1200,0x0,0x0,0x120,0x1320,0x120,0x0,0x240,0x1440,0x240,0x0,0x360,0x1560,0x360,0x0
.long 0x480,0x1680,0x480,0x0,0x5a0,0x17a0,0x5a0,0x0,0x6c0,0x18c0,0x6c0,0x0,0x7e0,0x19e0,0x7e0,0x0
.long 0x900,0x1b00,0x900,0x0,0x900,0x1b00,0xa20,0x0,0xa20,0x1b00,0xb40,0x0,0xb40,0x1b00,0xc60,0x0
.long 0xb40,0x1560,0xd80,0x0,0xb40,0x1560,0xea0,0x0,0xc60,0x1560,0xfc0,0x0,0xd80,0x1560,0x10e0,0x0
.long 0x10,0x1210,0x10,0x0,0x130,0x1330,0x130,0x0,0x250,0x1450,0x250,0x0,0x370,0x1570,0x370,0x0
.long 0x490,0x1690,0x490,0x0,0x5b0,0x17b0,0x5b0,0x0,0x6d0,0x18d0,0x6d0,0x0,0x7f0,0x19f0,0x7f0,0x0
.long 0x910,0x1b10,0x910,0x0,0x910,0x1b10,0xa30,0x0,0xa30,0x1b10,0xb50,0x0,0xb50,0x1b10,0xc70,0x0
.long 0xb50,0x1570,0xd90,0x0,0xb50,0x1570,0xeb0,0x0,0xc70,0x1570,0xfd0,0x0,0xd90,0x1570,0x10f0,0x0
.long 0x20,0x1220,0x20,0x0,0x140,0x1340,0x140,0x0,0x260,0x1460,0x260,0x0,0x380,0x1580,0x380,0x0
.long 0x4a0,0x16a0,0x4a0,0x0,0x5c0,0x17c0,0x5c0,0x0,0x6e0,0x18e0,0x6e0,0x0,0x800,0x1a00,0x800,0x0
.long 0x920,0x1b20,0x920,0x0,0x920,0x1b20,0xa40,0x0,0xa40,0x1b20,0xb60,0x0,0xb60,0x1b20,0xc80,0x0
.long 0xb60,0x1580,0xda0,0x0,0xb60,0x1580,0xec0,0x0,0xc80,0x1580,0xfe0,0x0,0xda0,0x1580,0x1100,0x0
.long 0x30,0x1230,0x30,0x0,0x150,0x1350,0x150,0x0,0x270,0x1470,0x270,0x0,0x390,0x1590,0x390,0x0
.long 0x4b0,0x16b0,0x4b0,0x0,0x5d0,0x17d0,0x5d0,0x0,0x6f0,0x18f0,0x6f0,0x0,0x810,0x1a10,0x810,0x0
.long 0x930,0x1b30,0x930,0x0,0x930,0x1b30,0xa50,0x0,0xa50,0x1b30,0xb70,0x0,0xb70,0x1b30,0xc90,0x0
.long 0xb70,0x1590,0xdb0,0x0,0xb70,0x1590,0xed0,0x0,0xc90,0x1590,0xff0,0x0,0xdb0,0x1590,0x1110,0x0
.size k_tables, 9216
L_tab_end:
.section .rodata,"a"
.p2align 6
.amdhsa_kernel gated_mix__spectral_gfnet__ssm_conv_s4__prompt_kernel
  .amdhsa_next_free_vgpr 128
  .amdhsa_next_free_sgpr 72
  .amdhsa_accum_offset 128
  .amdhsa_group_segment_fixed_size 0
  .amdhsa_kernarg_size 128
  .amdhsa_user_sgpr_count 2
  .amdhsa_user_sgpr_kernarg_segment_ptr 1
  .amdhsa_system_sgpr_workgroup_id_x 1
.end_amdhsa_kernel
```
